```python
import torch

def _softmax(x, axis=-1):
    return torch.softmax(x, dim=axis)
def _gelu(x):
    return torch.nn.functional.gelu(x, approximate="tanh")
def _silu(x):
    return torch.nn.functional.silu(x)
def _sigmoid(x):
    return torch.sigmoid(x)
def _layernorm(x, axis=-1, eps=1e-5):
    m = x.mean(dim=axis, keepdim=True)
    v = x.var(dim=axis, keepdim=True, unbiased=False)
    return (x - m) / torch.sqrt(v + eps)
def _scatter_add(tgt, idx, src, axis=0):
    return tgt.clone().index_add_(axis, idx, src)
def _segment_sum(src, seg, n):
    out = torch.zeros((n,) + src.shape[1:], dtype=src.dtype)
    return out.index_add_(0, seg, src)
def _pad(x, pw):
    flat = tuple(v for pair in reversed(pw) for v in pair)
    return torch.nn.functional.pad(x, flat)

kernel_name = 'gather_scatter__edge_featured_mpnn_mpnn__graph'

def setup_inputs():

    _w = (lambda a: (lambda t: t.to(torch.bfloat16) if t.is_floating_point() else t)(torch.as_tensor(a)))
    N, deg, D, De = 10000, 16, 128, max(4, 1)
    E = N * deg
    H = 2 * D
    return {
        "x": _w((lambda *s: torch.randn(*s, dtype=torch.bfloat16) * 0.05)(N, D)),
        "e_attr": _w((lambda *s: torch.randn(*s, dtype=torch.bfloat16) * 1.6)(E, De)),
        "src": _w((lambda lo, hi, *s: torch.randint(lo, hi, s))(0, N, E).to(torch.int64)),
        "dst": _w((lambda lo, hi, *s: torch.randint(lo, hi, s))(0, N, E).to(torch.int64)),
        "w1": _w((lambda *s: torch.randn(*s, dtype=torch.bfloat16) * 1.6)(2 * D + De, H) * (1.0 / (2 * D + De) ** 0.5)),
        "b1": _w((lambda *s: torch.randn(*s, dtype=torch.bfloat16) * 3.2)(H) * 0.01),
        "w2": _w((lambda *s: torch.randn(*s, dtype=torch.bfloat16) * 0.05)(H, D) * (1.0 / H ** 0.5)),
        "b2": _w((lambda *s: torch.randn(*s, dtype=torch.bfloat16) * 0.1)(D) * 0.01),
    }

def reference(x, e_attr, src, dst, w1, b1, w2, b2):
    N, D = x.shape
    h_src = x[src]
    h_dst = x[dst]
    m_in = torch.concatenate([h_src, h_dst, e_attr], axis=-1)
    h = _silu(m_in @ w1 + b1)
    msg = h @ w2 + b2
    return _segment_sum(msg, dst, N)
```

```asm
; @launch kernel=mpnn_pre_kernel grid=(456,1,1) block=(320,1,1) lds=65536
; @launch kernel=mpnn_main_kernel grid=(256,1,1) block=(512,1,1) lds=163840
.amdgcn_target "amdgcn-amd-amdhsa--gfx950"
.text
.globl mpnn_pre_kernel
.p2align 8
.type mpnn_pre_kernel,@function
mpnn_pre_kernel:
    s_cmp_ge_u32 s2, 456
    s_cbranch_scc1 K1_END
    s_load_dwordx16 s[4:19], s[0:1], 0
    s_load_dwordx2 s[20:21], s[0:1], 80
    v_lshrrev_b32 v2, 6, v0
    v_and_b32 v1, 63, v0
    v_readfirstlane_b32 s3, v2
    s_cmp_lt_u32 s2, 448
    s_cbranch_scc1 K1_NOPF
    s_getpc_b64 s[60:61]
K1_PC:
    s_mov_b32 s62, K2_END-K1_PC
    s_mov_b32 s63, 0x00020000
    v_lshlrev_b32 v60, 7, v0
    buffer_load_dword v61, v60, s[60:63], 0 offen
    s_endpgm
K1_NOPF:
    s_cmp_ge_u32 s2, 128
    s_cbranch_scc1 K1_gemm
    s_and_b32 s22, s2, 7
    s_lshl_b32 s22, s22, 4
    s_lshr_b32 s2, s2, 3
    s_add_u32 s2, s2, s22
    s_cmp_ge_u32 s2, 125
    s_cbranch_scc1 K1_END
    v_lshlrev_b32 v3, 4, v0
    v_lshlrev_b32 v4, 5, v0
    v_lshlrev_b32 v5, 2, v0
    v_mov_b32 v6, 0
    s_mul_i32 s22, s2, 5120
    s_mul_i32 s23, s2, 10240
    ds_write_b32 v5, v6 offset:16384
    s_waitcnt lgkmcnt(0)
    s_mov_b32 s24, s10
    s_mov_b32 s25, s11
    s_mov_b32 s26, 0x9c400
    s_mov_b32 s27, 0x00020000
    buffer_load_dwordx4 v[8:11], v3, s[24:27], s22 offen
    s_mov_b32 s32, s6
    s_mov_b32 s33, s7
    s_mov_b32 s34, 0x138800
    s_mov_b32 s35, 0x00020000
    s_mov_b32 s28, s8
    s_mov_b32 s29, s9
    s_mov_b32 s30, 0x9c400
    s_mov_b32 s31, 0x00020000
    s_branch K1_sort2
K1_gemm:
    s_sub_u32 s2, s2, 128
    s_cmp_eq_u32 s3, 4
    s_cbranch_scc1 K1_prep
    s_lshr_b32 s22, s2, 4
    s_and_b32 s23, s2, 7
    s_mul_i32 s23, s23, 20
    s_add_u32 s22, s22, s23
    s_cmp_ge_u32 s22, 157
    s_cbranch_scc1 K1_END
    s_bfe_u32 s23, s2, 0x10003
    s_and_b32 s36, s3, 1
    s_lshr_b32 s37, s3, 1
    v_lshrrev_b32 v3, 3, v1
    v_and_b32 v4, 7, v1
    v_lshlrev_b32 v4, 4, v4
    v_lshl_add_u32 v3, v3, 9, v4
    v_and_b32 v4, 16, v1
    v_lshlrev_b32 v4, 2, v4
    v_xor_b32 v3, v3, v4
    v_lshrrev_b32 v5, 4, v1
    v_and_b32 v6, 15, v1
    v_xor_b32 v6, v6, v5
    v_lshlrev_b32 v6, 4, v6
    v_lshl_add_u32 v8, v5, 8, v6
    v_xor_b32 v9, 64, v8
    v_xor_b32 v10, 128, v8
    v_xor_b32 v11, 192, v8
    s_lshl_b32 s38, s37, 15
    s_lshl_b32 s39, s23, 8
    s_add_u32 s38, s38, s39
    s_lshl_b32 s39, s36, 7
    s_add_u32 s38, s38, s39
    s_lshl_b32 s52, s36, 14
    s_lshl_b32 s39, s37, 13
    s_add_u32 s52, s52, s39
    s_lshl_b32 s53, s22, 1
    s_add_u32 s53, s53, s37
    s_lshl_b32 s54, s53, 13
    s_lshl_b32 s39, s36, 12
    s_add_u32 s54, s54, s39
    s_lshl_b32 s55, s37, 13
    s_add_u32 s55, s55, s39
    v_lshrrev_b32 v12, 5, v1
    s_lshl_b32 s58, s23, 8
    s_lshl_b32 s39, s36, 7
    s_add_u32 s58, s58, s39
    s_waitcnt lgkmcnt(0)
    s_add_u32 m0, s55, 32768
    s_mov_b32 s24, s4
    s_mov_b32 s25, s5
    s_mov_b32 s26, 0x271000
    s_mov_b32 s27, 0x00020000
    buffer_load_dwordx4 v8, s[24:27], s54 offen offset:0 lds
    buffer_load_dwordx4 v9, s[24:27], s54 offen offset:1024 lds
    buffer_load_dwordx4 v10, s[24:27], s54 offen offset:2048 lds
    buffer_load_dwordx4 v11, s[24:27], s54 offen offset:3072 lds
    s_mov_b32 s28, s12
    s_mov_b32 s29, s13
    s_mov_b32 s30, 0x20800
    s_mov_b32 s31, 0x00020000
    s_mov_b32 m0, s52
    s_add_u32 s52, s52, 1024
    buffer_load_dwordx4 v3, s[28:31], s38 offen lds
    s_add_u32 s38, s38, 4096
    s_mov_b32 m0, s52
    s_add_u32 s52, s52, 1024
    buffer_load_dwordx4 v3, s[28:31], s38 offen lds
    s_add_u32 s38, s38, 4096
    s_mov_b32 m0, s52
    s_add_u32 s52, s52, 1024
    buffer_load_dwordx4 v3, s[28:31], s38 offen lds
    s_add_u32 s38, s38, 4096
    s_mov_b32 m0, s52
    s_add_u32 s52, s52, 1024
    buffer_load_dwordx4 v3, s[28:31], s38 offen lds
    s_add_u32 s38, s38, 4096
    s_mov_b32 m0, s52
    s_add_u32 s52, s52, 1024
    buffer_load_dwordx4 v3, s[28:31], s38 offen lds
    s_add_u32 s38, s38, 4096
    s_mov_b32 m0, s52
    s_add_u32 s52, s52, 1024
    buffer_load_dwordx4 v3, s[28:31], s38 offen lds
    s_add_u32 s38, s38, 4096
    s_mov_b32 m0, s52
    s_add_u32 s52, s52, 1024
    buffer_load_dwordx4 v3, s[28:31], s38 offen lds
    s_add_u32 s38, s38, 4096
    s_mov_b32 m0, s52
    s_add_u32 s52, s52, 1024
    buffer_load_dwordx4 v3, s[28:31], s38 offen lds
    s_add_u32 s38, s38, 4096
    s_add_u32 s40, s20, 0x300000
    s_addc_u32 s41, s21, 0
    s_mov_b32 s42, 0x4e2000
    s_mov_b32 s43, 0x00020000
    s_add_u32 s44, s20, 0x830000
    s_addc_u32 s45, s21, 0
    s_mov_b32 s46, 0x13a0
    s_mov_b32 s47, 0x00020000
    v_and_b32 v13, 31, v1
    v_bfe_u32 v14, v1, 2, 2
    v_lshl_add_u32 v14, v12, 3, v14
    v_lshlrev_b32 v14, 7, v14
    v_and_b32 v15, 3, v1
    v_lshl_add_u32 v14, v15, 3, v14
    v_bfe_u32 v15, v1, 4, 1
    v_lshl_add_u32 v14, v15, 5, v14
    v_bfe_u32 v15, v1, 3, 1
    v_lshl_add_u32 v14, v15, 6, v14
    s_lshl_b32 s39, s36, 14
    v_add_u32 v14, s39, v14
    v_xor_b32 v26, 64, v14
    v_and_b32 v15, 15, v1
    v_xor_b32 v15, v15, v12
    v_lshlrev_b32 v15, 4, v15
    v_lshl_add_u32 v15, v13, 8, v15
    s_lshl_b32 s39, s37, 13
    s_add_u32 s39, s39, 32768
    v_add_u32 v16, s39, v15
    v_xor_b32 v17, 32, v16
    v_xor_b32 v18, 64, v16
    v_xor_b32 v19, 96, v16
    v_xor_b32 v20, 128, v16
    v_xor_b32 v21, 160, v16
    v_xor_b32 v22, 192, v16
    v_xor_b32 v23, 224, v16
    v_and_b32 v27, 7, v1
    v_lshlrev_b32 v27, 4, v27
    v_lshl_add_u32 v27, v13, 7, v27
    v_lshl_add_u32 v27, v12, 3, v27
    s_lshl_b32 s39, s3, 12
    s_add_u32 s39, s39, 49152
    v_add_u32 v27, s39, v27
    v_lshl_add_u32 v28, v1, 4, s39
    v_lshrrev_b32 v24, 3, v1
    v_and_b32 v25, 7, v1
    v_xor_b32 v25, v25, v24
    v_lshlrev_b32 v25, 4, v25
    v_lshl_add_u32 v24, v24, 9, v25
    s_lshl_b32 s56, s53, 14
    s_lshl_b32 s39, s23, 8
    s_add_u32 s56, s56, s39
    s_lshl_b32 s39, s36, 7
    s_add_u32 s56, s56, s39
    s_mov_b32 s57, 0xbfb8aa3b
    s_add_u32 s62, s14, s58
    s_addc_u32 s63, s15, 0
    s_load_dwordx16 s[64:79], s[62:63], 0
    s_load_dwordx16 s[4:19], s[62:63], 64
    v_mov_b32 v31, 0xffff0000
    s_waitcnt lgkmcnt(0)
    s_mov_b32 exec_lo, -1
    s_mov_b32 exec_hi, 0
    v_lshlrev_b32_e64 v96, 16, s64
    v_and_b32 v97, s64, v31
    v_lshlrev_b32_e64 v98, 16, s65
    v_and_b32 v99, s65, v31
    v_lshlrev_b32_e64 v100, 16, s68
    v_and_b32 v101, s68, v31
    v_lshlrev_b32_e64 v102, 16, s69
    v_and_b32 v103, s69, v31
    v_lshlrev_b32_e64 v104, 16, s72
    v_and_b32 v105, s72, v31
    v_lshlrev_b32_e64 v106, 16, s73
    v_and_b32 v107, s73, v31
    v_lshlrev_b32_e64 v108, 16, s76
    v_and_b32 v109, s76, v31
    v_lshlrev_b32_e64 v110, 16, s77
    v_and_b32 v111, s77, v31
    v_lshlrev_b32_e64 v112, 16, s4
    v_and_b32 v113, s4, v31
    v_lshlrev_b32_e64 v114, 16, s5
    v_and_b32 v115, s5, v31
    v_lshlrev_b32_e64 v116, 16, s8
    v_and_b32 v117, s8, v31
    v_lshlrev_b32_e64 v118, 16, s9
    v_and_b32 v119, s9, v31
    v_lshlrev_b32_e64 v120, 16, s12
    v_and_b32 v121, s12, v31
    v_lshlrev_b32_e64 v122, 16, s13
    v_and_b32 v123, s13, v31
    v_lshlrev_b32_e64 v124, 16, s16
    v_and_b32 v125, s16, v31
    v_lshlrev_b32_e64 v126, 16, s17
    v_and_b32 v127, s17, v31
    s_mov_b32 exec_lo, 0
    s_mov_b32 exec_hi, -1
    v_lshlrev_b32_e64 v96, 16, s66
    v_and_b32 v97, s66, v31
    v_lshlrev_b32_e64 v98, 16, s67
    v_and_b32 v99, s67, v31
    v_lshlrev_b32_e64 v100, 16, s70
    v_and_b32 v101, s70, v31
    v_lshlrev_b32_e64 v102, 16, s71
    v_and_b32 v103, s71, v31
    v_lshlrev_b32_e64 v104, 16, s74
    v_and_b32 v105, s74, v31
    v_lshlrev_b32_e64 v106, 16, s75
    v_and_b32 v107, s75, v31
    v_lshlrev_b32_e64 v108, 16, s78
    v_and_b32 v109, s78, v31
    v_lshlrev_b32_e64 v110, 16, s79
    v_and_b32 v111, s79, v31
    v_lshlrev_b32_e64 v112, 16, s6
    v_and_b32 v113, s6, v31
    v_lshlrev_b32_e64 v114, 16, s7
    v_and_b32 v115, s7, v31
    v_lshlrev_b32_e64 v116, 16, s10
    v_and_b32 v117, s10, v31
    v_lshlrev_b32_e64 v118, 16, s11
    v_and_b32 v119, s11, v31
    v_lshlrev_b32_e64 v120, 16, s14
    v_and_b32 v121, s14, v31
    v_lshlrev_b32_e64 v122, 16, s15
    v_and_b32 v123, s15, v31
    v_lshlrev_b32_e64 v124, 16, s18
    v_and_b32 v125, s18, v31
    v_lshlrev_b32_e64 v126, 16, s19
    v_and_b32 v127, s19, v31
    s_mov_b64 exec, -1
    s_waitcnt vmcnt(0)
    s_barrier
    ds_read_b128 v[32:35], v16
    ds_read_b64_tr_b16 v[64:65], v14 offset:0
    ds_read_b64_tr_b16 v[66:67], v14 offset:512
    ds_read_b128 v[36:39], v17
    ds_read_b64_tr_b16 v[68:69], v14 offset:2048
    ds_read_b64_tr_b16 v[70:71], v14 offset:2560
    ds_read_b128 v[40:43], v18
    ds_read_b64_tr_b16 v[72:73], v14 offset:4096
    ds_read_b64_tr_b16 v[74:75], v14 offset:4608
    ds_read_b128 v[44:47], v19
    ds_read_b64_tr_b16 v[76:77], v14 offset:6144
    ds_read_b64_tr_b16 v[78:79], v14 offset:6656
    s_waitcnt lgkmcnt(9)
    v_mfma_f32_32x32x16_bf16 v[96:111], v[64:67], v[32:35], v[96:111]
    ds_read_b128 v[48:51], v20
    ds_read_b64_tr_b16 v[80:81], v14 offset:8192
    ds_read_b64_tr_b16 v[82:83], v14 offset:8704
    s_waitcnt lgkmcnt(9)
    v_mfma_f32_32x32x16_bf16 v[96:111], v[68:71], v[36:39], v[96:111]
    ds_read_b128 v[52:55], v21
    ds_read_b64_tr_b16 v[84:85], v14 offset:10240
    ds_read_b64_tr_b16 v[86:87], v14 offset:10752
    s_waitcnt lgkmcnt(9)
    v_mfma_f32_32x32x16_bf16 v[96:111], v[72:75], v[40:43], v[96:111]
    ds_read_b128 v[56:59], v22
    ds_read_b64_tr_b16 v[88:89], v14 offset:12288
    ds_read_b64_tr_b16 v[90:91], v14 offset:12800
    s_waitcnt lgkmcnt(9)
    v_mfma_f32_32x32x16_bf16 v[96:111], v[76:79], v[44:47], v[96:111]
    ds_read_b128 v[60:63], v23
    ds_read_b64_tr_b16 v[92:93], v14 offset:14336
    ds_read_b64_tr_b16 v[94:95], v14 offset:14848
    s_waitcnt lgkmcnt(9)
    v_mfma_f32_32x32x16_bf16 v[96:111], v[80:83], v[48:51], v[96:111]
    ds_read_b64_tr_b16 v[64:65], v26 offset:0
    ds_read_b64_tr_b16 v[66:67], v26 offset:512
    s_waitcnt lgkmcnt(8)
    v_mfma_f32_32x32x16_bf16 v[96:111], v[84:87], v[52:55], v[96:111]
    ds_read_b64_tr_b16 v[68:69], v26 offset:2048
    ds_read_b64_tr_b16 v[70:71], v26 offset:2560
    s_waitcnt lgkmcnt(7)
    v_mfma_f32_32x32x16_bf16 v[96:111], v[88:91], v[56:59], v[96:111]
    ds_read_b64_tr_b16 v[72:73], v26 offset:4096
    ds_read_b64_tr_b16 v[74:75], v26 offset:4608
    s_waitcnt lgkmcnt(6)
    v_mfma_f32_32x32x16_bf16 v[96:111], v[92:95], v[60:63], v[96:111]
    ds_read_b64_tr_b16 v[76:77], v26 offset:6144
    ds_read_b64_tr_b16 v[78:79], v26 offset:6656
    s_waitcnt lgkmcnt(6)
    v_mfma_f32_32x32x16_bf16 v[112:127], v[64:67], v[32:35], v[112:127]
    ds_read_b64_tr_b16 v[80:81], v26 offset:8192
    ds_read_b64_tr_b16 v[82:83], v26 offset:8704
    s_waitcnt lgkmcnt(6)
    v_mfma_f32_32x32x16_bf16 v[112:127], v[68:71], v[36:39], v[112:127]
    ds_read_b64_tr_b16 v[84:85], v26 offset:10240
    ds_read_b64_tr_b16 v[86:87], v26 offset:10752
    s_waitcnt lgkmcnt(6)
    v_mfma_f32_32x32x16_bf16 v[112:127], v[72:75], v[40:43], v[112:127]
    ds_read_b64_tr_b16 v[88:89], v26 offset:12288
    ds_read_b64_tr_b16 v[90:91], v26 offset:12800
    s_waitcnt lgkmcnt(6)
    v_mfma_f32_32x32x16_bf16 v[112:127], v[76:79], v[44:47], v[112:127]
    ds_read_b64_tr_b16 v[92:93], v26 offset:14336
    ds_read_b64_tr_b16 v[94:95], v26 offset:14848
    v_mul_f32 v96, s57, v96
    v_mul_f32 v97, s57, v97
    v_mul_f32 v98, s57, v98
    v_mul_f32 v99, s57, v99
    v_mul_f32 v100, s57, v100
    v_mul_f32 v101, s57, v101
    v_mul_f32 v102, s57, v102
    s_waitcnt lgkmcnt(6)
    v_mfma_f32_32x32x16_bf16 v[112:127], v[80:83], v[48:51], v[112:127]
    v_mul_f32 v103, s57, v103
    v_mul_f32 v104, s57, v104
    v_mul_f32 v105, s57, v105
    v_mul_f32 v106, s57, v106
    v_mul_f32 v107, s57, v107
    v_mul_f32 v108, s57, v108
    v_mul_f32 v109, s57, v109
    s_waitcnt lgkmcnt(4)
    v_mfma_f32_32x32x16_bf16 v[112:127], v[84:87], v[52:55], v[112:127]
    v_mul_f32 v110, s57, v110
    v_mul_f32 v111, s57, v111
    v_xor_b32 v29, 0, v27
    v_cvt_pk_bf16_f32 v8, v96, v97
    v_cvt_pk_bf16_f32 v9, v98, v99
    ds_write_b64 v29, v[8:9]
    v_xor_b32 v30, 16, v27
    s_waitcnt lgkmcnt(3)
    v_mfma_f32_32x32x16_bf16 v[112:127], v[88:91], v[56:59], v[112:127]
    v_cvt_pk_bf16_f32 v10, v100, v101
    v_cvt_pk_bf16_f32 v11, v102, v103
    ds_write_b64 v30, v[10:11]
    v_xor_b32 v29, 32, v27
    v_cvt_pk_bf16_f32 v12, v104, v105
    v_cvt_pk_bf16_f32 v13, v106, v107
    ds_write_b64 v29, v[12:13]
    s_waitcnt lgkmcnt(3)
    v_mfma_f32_32x32x16_bf16 v[112:127], v[92:95], v[60:63], v[112:127]
    v_xor_b32 v30, 48, v27
    v_cvt_pk_bf16_f32 v14, v108, v109
    v_cvt_pk_bf16_f32 v15, v110, v111
    ds_write_b64 v30, v[14:15]
    v_max_f32 v25, |v96|, |v97|
    v_max3_f32 v25, |v98|, |v99|, v25
    v_max3_f32 v25, |v100|, |v101|, v25
    v_max3_f32 v25, |v102|, |v103|, v25
    v_max3_f32 v25, |v104|, |v105|, v25
    v_max3_f32 v25, |v106|, |v107|, v25
    v_max3_f32 v25, |v108|, |v109|, v25
    v_max3_f32 v25, |v110|, |v111|, v25
    s_nop 1
    v_mul_f32 v112, s57, v112
    v_mul_f32 v113, s57, v113
    v_mul_f32 v114, s57, v114
    v_mul_f32 v115, s57, v115
    v_mul_f32 v116, s57, v116
    v_mul_f32 v117, s57, v117
    v_mul_f32 v118, s57, v118
    v_mul_f32 v119, s57, v119
    v_mul_f32 v120, s57, v120
    v_mul_f32 v121, s57, v121
    v_mul_f32 v122, s57, v122
    v_mul_f32 v123, s57, v123
    v_mul_f32 v124, s57, v124
    v_mul_f32 v125, s57, v125
    v_mul_f32 v126, s57, v126
    v_mul_f32 v127, s57, v127
    v_xor_b32 v29, 64, v27
    v_cvt_pk_bf16_f32 v8, v112, v113
    v_cvt_pk_bf16_f32 v9, v114, v115
    ds_write_b64 v29, v[8:9]
    v_xor_b32 v30, 80, v27
    v_cvt_pk_bf16_f32 v10, v116, v117
    v_cvt_pk_bf16_f32 v11, v118, v119
    ds_write_b64 v30, v[10:11]
    v_xor_b32 v29, 96, v27
    v_cvt_pk_bf16_f32 v12, v120, v121
    v_cvt_pk_bf16_f32 v13, v122, v123
    ds_write_b64 v29, v[12:13]
    v_xor_b32 v30, 112, v27
    v_cvt_pk_bf16_f32 v14, v124, v125
    v_cvt_pk_bf16_f32 v15, v126, v127
    ds_write_b64 v30, v[14:15]
    ds_read_b128 v[32:35], v28 offset:0
    ds_read_b128 v[36:39], v28 offset:1024
    ds_read_b128 v[40:43], v28 offset:2048
    ds_read_b128 v[44:47], v28 offset:3072
    v_max3_f32 v25, |v112|, |v113|, v25
    v_max3_f32 v25, |v114|, |v115|, v25
    v_max3_f32 v25, |v116|, |v117|, v25
    v_max3_f32 v25, |v118|, |v119|, v25
    v_max3_f32 v25, |v120|, |v121|, v25
    v_max3_f32 v25, |v122|, |v123|, v25
    v_max3_f32 v25, |v124|, |v125|, v25
    v_max3_f32 v25, |v126|, |v127|, v25
    s_nop 1
    v_max_u32_dpp v25, v25, v25 row_shr:1 row_mask:0xf bank_mask:0xf bound_ctrl:0
    s_nop 1
    v_max_u32_dpp v25, v25, v25 row_shr:2 row_mask:0xf bank_mask:0xf bound_ctrl:0
    s_nop 1
    v_max_u32_dpp v25, v25, v25 row_shr:4 row_mask:0xf bank_mask:0xf bound_ctrl:0
    s_nop 1
    v_max_u32_dpp v25, v25, v25 row_shr:8 row_mask:0xf bank_mask:0xf bound_ctrl:0
    s_nop 1
    v_max_u32_dpp v25, v25, v25 row_bcast:15 row_mask:0xa bank_mask:0xf
    s_nop 1
    v_max_u32_dpp v25, v25, v25 row_bcast:31 row_mask:0xc bank_mask:0xf
    s_lshl_b32 s39, s22, 1
    s_add_u32 s39, s39, s23
    s_lshl_b32 s39, s39, 4
    s_lshl_b32 s36, s3, 2
    s_add_u32 s39, s39, s36
    v_mov_b32 v26, 0
    s_waitcnt lgkmcnt(3)
    buffer_store_dwordx4 v[32:35], v24, s[40:43], s56 offen nt
    s_add_u32 s56, s56, 4096
    s_waitcnt lgkmcnt(2)
    buffer_store_dwordx4 v[36:39], v24, s[40:43], s56 offen nt
    s_add_u32 s56, s56, 4096
    s_waitcnt lgkmcnt(1)
    buffer_store_dwordx4 v[40:43], v24, s[40:43], s56 offen nt
    s_add_u32 s56, s56, 4096
    s_waitcnt lgkmcnt(0)
    buffer_store_dwordx4 v[44:47], v24, s[40:43], s56 offen nt
K1G_st:
    s_mov_b32 exec_lo, 0
    s_mov_b32 exec_hi, 0x80000000
    buffer_store_dword v25, v26, s[44:47], s39 offen
    s_endpgm
K1_sort2:
    s_mov_b32 s40, s20
    s_mov_b32 s41, s21
    s_mov_b32 s42, 0x1d4c00
    s_mov_b32 s43, 0x00020000
    s_add_u32 s44, s20, 0x280000
    s_addc_u32 s45, s21, 0
    s_mov_b32 s46, 0x20000
    s_mov_b32 s47, 0x00020000
    s_add_u32 s48, s20, 0x831400
    s_addc_u32 s49, s21, 0
    s_mov_b32 s50, 0x9c4
    s_mov_b32 s51, 0x00020000
    v_mov_b32 v32, 1
    s_movk_i32 s37, 3355
    s_mov_b32 s52, 0x7fff7fff
    v_lshlrev_b32 v33, 4, v1
    s_barrier
    s_waitcnt vmcnt(0)
    buffer_load_dwordx4 v[16:19], v4, s[32:35], s23 offen
    buffer_load_dwordx4 v[20:23], v4, s[32:35], s23 offen offset:16
    buffer_load_dwordx4 v[12:15], v3, s[28:31], s22 offen
    v_mul_u32_u24 v24, s37, v8
    v_mul_u32_u24 v25, s37, v9
    v_mul_u32_u24 v26, s37, v10
    v_mul_u32_u24 v27, s37, v11
    v_lshrrev_b32 v24, 17, v24
    v_lshrrev_b32 v25, 17, v25
    v_lshrrev_b32 v26, 17, v26
    v_lshrrev_b32 v27, 17, v27
    v_lshlrev_b32 v24, 2, v24
    ds_add_rtn_u32 v28, v24, v32 offset:16384
    v_lshlrev_b32 v25, 2, v25
    ds_add_rtn_u32 v29, v25, v32 offset:16384
    v_lshlrev_b32 v26, 2, v26
    ds_add_rtn_u32 v30, v26, v32 offset:16384
    v_lshlrev_b32 v27, 2, v27
    ds_add_rtn_u32 v31, v27, v32 offset:16384
    s_waitcnt lgkmcnt(0)
    s_barrier
    ds_read_b128 v[40:43], v33 offset:16384
    s_waitcnt lgkmcnt(0)
    v_add_u32 v50, v40, v41
    v_add_u32 v51, v50, v42
    v_add_u32 v57, v51, v43
    s_nop 1
    v_add_u32_dpp v56, v57, v57 row_shr:1 row_mask:0xf bank_mask:0xf bound_ctrl:0
    s_nop 1
    v_add_u32_dpp v56, v56, v56 row_shr:2 row_mask:0xf bank_mask:0xf bound_ctrl:0
    s_nop 1
    v_add_u32_dpp v56, v56, v56 row_shr:4 row_mask:0xf bank_mask:0xf bound_ctrl:0
    s_nop 1
    v_add_u32_dpp v56, v56, v56 row_shr:8 row_mask:0xf bank_mask:0xf bound_ctrl:0
    s_nop 1
    v_add_u32_dpp v56, v56, v56 row_bcast:15 row_mask:0xa bank_mask:0xf
    s_nop 1
    v_add_u32_dpp v56, v56, v56 row_bcast:31 row_mask:0xc bank_mask:0xf
    v_sub_u32 v48, v56, v57
    v_add_u32 v49, v48, v40
    v_add_u32 v50, v48, v50
    v_add_u32 v51, v48, v51
    ds_write_b128 v33, v[48:51] offset:18432
    ds_read_b32 v24, v24 offset:18432
    ds_read_b32 v25, v25 offset:18432
    ds_read_b32 v26, v26 offset:18432
    ds_read_b32 v27, v27 offset:18432
    v_lshlrev_b32 v33, 11, v1
    s_lshl_b32 s53, s2, 2
    s_cmp_lg_u32 s3, 0
    s_cbranch_scc1 K1S_t0
    v_lshl_or_b32 v40, v40, 16, v48
    buffer_store_dword v40, v33, s[44:47], s53 offen offset:0
    s_waitcnt vmcnt(1)
    s_branch K1S_j
K1S_t0:
    s_cmp_lg_u32 s3, 1
    s_cbranch_scc1 K1S_t1
    v_lshl_or_b32 v41, v41, 16, v49
    buffer_store_dword v41, v33, s[44:47], s53 offen offset:512
    s_waitcnt vmcnt(1)
    s_branch K1S_j
K1S_t1:
    s_cmp_lg_u32 s3, 2
    s_cbranch_scc1 K1S_t2
    v_lshl_or_b32 v42, v42, 16, v50
    buffer_store_dword v42, v33, s[44:47], s53 offen offset:1024
    s_waitcnt vmcnt(1)
    s_branch K1S_j
K1S_t2:
    s_cmp_lg_u32 s3, 3
    s_cbranch_scc1 K1S_t3
    v_lshl_or_b32 v43, v43, 16, v51
    buffer_store_dword v43, v33, s[44:47], s53 offen offset:1536
    s_waitcnt vmcnt(1)
    s_branch K1S_j
K1S_t3:
    s_waitcnt vmcnt(0)
K1S_j:
    s_mul_i32 s53, s2, 15360
    v_lshl_or_b32 v12, v8, 14, v12
    v_lshl_or_b32 v13, v9, 14, v13
    v_lshl_or_b32 v14, v10, 14, v14
    v_lshl_or_b32 v15, v11, 14, v15
    s_waitcnt lgkmcnt(3)
    v_add_u32 v24, v24, v28
    v_mul_u32_u24 v24, 12, v24
    ds_write2_b32 v24, v16, v17 offset0:0 offset1:1
    ds_write_b32 v24, v12 offset:8
    s_waitcnt lgkmcnt(4)
    v_add_u32 v25, v25, v29
    v_mul_u32_u24 v25, 12, v25
    ds_write2_b32 v25, v18, v19 offset0:0 offset1:1
    ds_write_b32 v25, v13 offset:8
    s_waitcnt lgkmcnt(5)
    v_add_u32 v26, v26, v30
    v_mul_u32_u24 v26, 12, v26
    ds_write2_b32 v26, v20, v21 offset0:0 offset1:1
    ds_write_b32 v26, v14 offset:8
    s_waitcnt lgkmcnt(6)
    v_add_u32 v27, v27, v31
    v_mul_u32_u24 v27, 12, v27
    ds_write2_b32 v27, v22, v23 offset0:0 offset1:1
    ds_write_b32 v27, v15 offset:8
    v_and_b32 v60, s52, v16
    v_and_b32 v61, s52, v17
    v_and_b32 v62, s52, v18
    v_and_b32 v63, s52, v19
    v_and_b32 v64, s52, v20
    v_and_b32 v65, s52, v21
    v_and_b32 v66, s52, v22
    v_and_b32 v67, s52, v23
    v_pk_max_u16 v60, v60, v61
    v_pk_max_u16 v62, v62, v63
    v_pk_max_u16 v64, v64, v65
    v_pk_max_u16 v66, v66, v67
    v_pk_max_u16 v60, v60, v62
    v_pk_max_u16 v64, v64, v66
    v_pk_max_u16 v60, v60, v64
    v_lshlrev_b32 v61, 16, v60
    v_and_b32 v60, 0xffff0000, v60
    v_max_u32 v60, v60, v61
    s_waitcnt lgkmcnt(0)
    s_barrier
    ds_read_b128 v[68:71], v3 offset:0
    ds_read_b128 v[72:75], v3 offset:5120
    ds_read_b128 v[76:79], v3 offset:10240
    s_nop 1
    v_max_u32_dpp v60, v60, v60 row_shr:1 row_mask:0xf bank_mask:0xf bound_ctrl:0
    s_nop 1
    v_max_u32_dpp v60, v60, v60 row_shr:2 row_mask:0xf bank_mask:0xf bound_ctrl:0
    s_nop 1
    v_max_u32_dpp v60, v60, v60 row_shr:4 row_mask:0xf bank_mask:0xf bound_ctrl:0
    s_nop 1
    v_max_u32_dpp v60, v60, v60 row_shr:8 row_mask:0xf bank_mask:0xf bound_ctrl:0
    s_nop 1
    v_max_u32_dpp v60, v60, v60 row_bcast:15 row_mask:0xa bank_mask:0xf
    s_nop 1
    v_max_u32_dpp v60, v60, v60 row_bcast:31 row_mask:0xc bank_mask:0xf
    s_waitcnt lgkmcnt(2)
    buffer_store_dwordx4 v[68:71], v3, s[40:43], s53 offen
    s_add_u32 s53, s53, 5120
    s_waitcnt lgkmcnt(1)
    buffer_store_dwordx4 v[72:75], v3, s[40:43], s53 offen
    s_add_u32 s53, s53, 5120
    s_waitcnt lgkmcnt(0)
    buffer_store_dwordx4 v[76:79], v3, s[40:43], s53 offen
    s_mov_b32 exec_lo, 0
    s_mov_b32 exec_hi, 0x80000000
    s_mul_i32 s54, s2, 20
    s_lshl_b32 s55, s3, 2
    s_add_u32 s54, s54, s55
    buffer_store_dword v60, v6, s[48:51], s54 offen
    s_endpgm
K1_prep:
    s_cmp_ge_u32 s2, 144
    s_cbranch_scc1 K1_END
    v_and_b32 v3, 31, v1
    v_lshlrev_b32 v3, 1, v3
    v_lshrrev_b32 v4, 5, v1
    v_lshlrev_b32 v5, 4, v1
    s_mov_b32 s38, 0xbfb8aa3b
    s_lshl_b32 s22, s2, 10
    s_waitcnt lgkmcnt(0)
    s_add_u32 s40, s20, 0x800000
    s_addc_u32 s41, s21, 0
    s_mov_b32 s42, 0x24000
    s_mov_b32 s43, 0x00020000
    s_mov_b32 s24, s12
    s_mov_b32 s25, s13
    s_mov_b32 s26, 0x20800
    s_mov_b32 s27, 0x00020000
    s_cmp_ge_u32 s2, 136
    s_cbranch_scc1 K1P_cst
    s_cmp_ge_u32 s2, 64
    s_cbranch_scc1 K1P_w2
    v_lshl_add_u32 v3, v4, 12, v3
    s_lshr_b32 s23, s2, 3
    s_and_b32 s36, s2, 7
    s_lshl_b32 s23, s23, 6
    s_lshl_b32 s36, s36, 13
    s_add_u32 s23, s23, s36
    s_add_u32 s23, s23, 0x10000
    buffer_load_ushort v8, v3, s[24:27], s23 offen offset:0
    buffer_load_ushort v9, v3, s[24:27], s23 offen offset:512
    buffer_load_ushort v10, v3, s[24:27], s23 offen offset:1024
    buffer_load_ushort v11, v3, s[24:27], s23 offen offset:1536
    buffer_load_ushort v12, v3, s[24:27], s23 offen offset:2048
    buffer_load_ushort v13, v3, s[24:27], s23 offen offset:2560
    buffer_load_ushort v14, v3, s[24:27], s23 offen offset:3072
    buffer_load_ushort v15, v3, s[24:27], s23 offen offset:3584
    s_barrier
    s_waitcnt vmcnt(0)
    v_lshlrev_b32 v8, 16, v8
    v_lshlrev_b32 v9, 16, v9
    v_lshlrev_b32 v10, 16, v10
    v_lshlrev_b32 v11, 16, v11
    v_lshlrev_b32 v12, 16, v12
    v_lshlrev_b32 v13, 16, v13
    v_lshlrev_b32 v14, 16, v14
    v_lshlrev_b32 v15, 16, v15
    v_mul_f32 v8, s38, v8
    v_mul_f32 v9, s38, v9
    v_mul_f32 v10, s38, v10
    v_mul_f32 v11, s38, v11
    v_mul_f32 v12, s38, v12
    v_mul_f32 v13, s38, v13
    v_mul_f32 v14, s38, v14
    v_mul_f32 v15, s38, v15
    v_cvt_pk_bf16_f32 v16, v8, v9
    v_cvt_pk_bf16_f32 v17, v10, v11
    v_cvt_pk_bf16_f32 v18, v12, v13
    v_cvt_pk_bf16_f32 v19, v14, v15
    buffer_store_dwordx4 v[16:19], v5, s[40:43], s22 offen
    s_endpgm
K1P_w2:
    s_sub_u32 s37, s2, 64
    s_mul_i32 s23, s37, 57
    s_lshr_b32 s23, s23, 9
    s_mul_i32 s36, s23, 9
    s_sub_u32 s36, s37, s36
    s_lshl_b32 s23, s23, 5
    v_and_b32 v3, 15, v1
    v_lshlrev_b32 v3, 1, v3
    s_cmp_eq_u32 s36, 8
    s_cbranch_scc1 K1P_b2
    s_mov_b32 s24, s16
    s_mov_b32 s25, s17
    s_mov_b32 s26, 0x10000
    s_mov_b32 s27, 0x00020000
    v_lshl_add_u32 v3, v4, 12, v3
    v_bfe_u32 v6, v1, 4, 1
    v_lshl_add_u32 v3, v6, 10, v3
    s_lshl_b32 s36, s36, 13
    s_add_u32 s23, s23, s36
    buffer_load_ushort v8, v3, s[24:27], s23 offen offset:0
    buffer_load_ushort v9, v3, s[24:27], s23 offen offset:256
    buffer_load_ushort v10, v3, s[24:27], s23 offen offset:512
    buffer_load_ushort v11, v3, s[24:27], s23 offen offset:768
    buffer_load_ushort v12, v3, s[24:27], s23 offen offset:2048
    buffer_load_ushort v13, v3, s[24:27], s23 offen offset:2304
    buffer_load_ushort v14, v3, s[24:27], s23 offen offset:2560
    buffer_load_ushort v15, v3, s[24:27], s23 offen offset:2816
    s_barrier
    s_waitcnt vmcnt(0)
    v_lshl_or_b32 v16, v9, 16, v8
    v_lshl_or_b32 v17, v11, 16, v10
    v_lshl_or_b32 v18, v13, 16, v12
    v_lshl_or_b32 v19, v15, 16, v14
    buffer_store_dwordx4 v[16:19], v5, s[40:43], s22 offen
    s_endpgm
K1P_b2:
    s_mov_b32 s24, s18
    s_mov_b32 s25, s19
    s_mov_b32 s26, 0x100
    s_mov_b32 s27, 0x00020000
    v_lshrrev_b32 v3, 4, v1
    v_lshlrev_b32 v3, 3, v3
    buffer_load_dwordx2 v[8:9], v3, s[24:27], s23 offen
    s_barrier
    s_waitcnt vmcnt(0)
    v_lshlrev_b32 v16, 16, v8
    v_and_b32 v17, 0xffff0000, v8
    v_lshlrev_b32 v18, 16, v9
    v_and_b32 v19, 0xffff0000, v9
    buffer_store_dwordx4 v[16:19], v5, s[40:43], s22 offen
    s_endpgm
K1P_cst:
    s_sub_u32 s37, s2, 136
    s_lshl_b32 s23, s37, 6
    s_add_u32 s36, s23, 0x20000
    buffer_load_ushort v8, v3, s[24:27], s36 offen offset:0
    buffer_load_ushort v9, v3, s[24:27], s36 offen offset:512
    buffer_load_ushort v10, v3, s[24:27], s36 offen offset:1024
    buffer_load_ushort v11, v3, s[24:27], s36 offen offset:1536
    v_mov_b32 v18, 0
    s_barrier
    s_waitcnt vmcnt(0)
    v_lshlrev_b32 v8, 16, v8
    v_lshlrev_b32 v9, 16, v9
    v_lshlrev_b32 v10, 16, v10
    v_lshlrev_b32 v11, 16, v11
    v_mul_f32 v8, s38, v8
    v_mul_f32 v9, s38, v9
    v_mul_f32 v10, s38, v10
    v_mul_f32 v11, s38, v11
    v_add_f32 v19, |v8|, |v9|
    v_add_f32 v19, |v10|, v19
    v_add_f32 v19, |v11|, v19
    v_cvt_pk_bf16_f32 v16, v8, v9
    v_cvt_pk_bf16_f32 v17, v10, v11
    buffer_store_dwordx4 v[16:19], v5, s[40:43], s22 offen
K1_END:
    s_endpgm
.text
.globl mpnn_main_kernel
.p2align 8
.type mpnn_main_kernel,@function
mpnn_main_kernel:
    s_cmp_ge_u32 s2, 256
    s_cbranch_scc1 K2_END
    s_load_dwordx2 s[22:23], s[0:1], 80
    s_load_dwordx2 s[4:5], s[0:1], 0
    s_load_dwordx2 s[20:21], s[0:1], 64
    v_lshrrev_b32 v2, 6, v0
    v_and_b32 v1, 63, v0
    v_readfirstlane_b32 s3, v2
    v_mov_b32 v128, 0
    s_lshl_b32 m0, s3, 8
    s_nop 0
    ds_write_addtid_b32 v128 offset:0
    ds_write_addtid_b32 v128 offset:2048
    ds_write_addtid_b32 v128 offset:4096
    ds_write_addtid_b32 v128 offset:6144
    ds_write_addtid_b32 v128 offset:8192
    ds_write_addtid_b32 v128 offset:10240
    ds_write_addtid_b32 v128 offset:12288
    ds_write_addtid_b32 v128 offset:14336
    ds_write_addtid_b32 v128 offset:16384
    ds_write_addtid_b32 v128 offset:18432
    ds_write_addtid_b32 v128 offset:20480
    ds_write_addtid_b32 v128 offset:22528
    ds_write_addtid_b32 v128 offset:24576
    ds_write_addtid_b32 v128 offset:26624
    s_and_b32 s76, s2, 7
    s_lshr_b32 s2, s2, 3
    s_lshl_b32 s76, s76, 5
    s_add_u32 s2, s2, s76
    s_lshr_b32 s52, s3, 2
    v_lshrrev_b32 v3, 2, v0
    v_lshlrev_b32 v7, 2, v3
    v_mov_b32 v184, 0
    v_cmp_gt_u32 vcc, 125, v3
    s_lshl_b32 s79, s2, 9
    s_mov_b32 s26, 0x20000
    s_mov_b32 s27, 0x00020000
    s_and_b32 s53, s3, 3
    s_lshl_b32 s76, s2, 17
    s_add_u32 s76, s76, 3354
    s_add_u32 s78, s76, 0x20000
    s_mul_hi_u32 s54, s76, 0x1388a917
    s_mul_hi_u32 s78, s78, 0x1388a917
    s_lshr_b32 s54, s54, 8
    s_lshr_b32 s78, s78, 8
    s_min_u32 s78, s78, 10000
    s_sub_u32 s57, s78, s54
    s_lshl_b32 s11, s3, 13
    s_add_u32 s64, s11, 98304
    s_mov_b64 exec, vcc
    s_waitcnt lgkmcnt(0)
    s_add_u32 s24, s22, 0x280000
    s_addc_u32 s25, s23, 0
    buffer_load_dword v184, v7, s[24:27], s79 offen
    s_mov_b64 exec, -1
    s_lshl_b32 m0, s3, 8
    s_nop 0
    ds_write_addtid_b32 v128 offset:28672
    ds_write_addtid_b32 v128 offset:30720
    ds_write_addtid_b32 v128 offset:32768
    ds_write_addtid_b32 v128 offset:34816
    ds_write_addtid_b32 v128 offset:36864
    ds_write_addtid_b32 v128 offset:38912
    ds_write_addtid_b32 v128 offset:40960
    ds_write_addtid_b32 v128 offset:43008
    ds_write_addtid_b32 v128 offset:45056
    ds_write_addtid_b32 v128 offset:47104
    ds_write_addtid_b32 v128 offset:49152
    ds_write_addtid_b32 v128 offset:51200
    ds_write_addtid_b32 v128 offset:53248
    s_min_u32 s76, s3, 6
    s_lshl_b32 m0, s76, 8
    s_nop 0
    ds_write_addtid_b32 v128 offset:55296
    v_lshrrev_b32 v5, 4, v1
    v_and_b32 v6, 15, v1
    v_xor_b32 v6, v6, v5
    s_lshl_b32 s77, s53, 2
    v_xor_b32 v6, s77, v6
    v_lshlrev_b32 v6, 4, v6
    v_lshl_add_u32 v6, v5, 8, v6
    v_lshlrev_b32 v4, 4, v1
    s_lshl_b32 s77, s54, 8
    s_lshl_b32 s78, s3, 10
    s_add_u32 s77, s77, s78
    s_add_u32 m0, s78, 64512
    s_mov_b32 s36, s4
    s_mov_b32 s37, s5
    s_mov_b32 s38, 0x271000
    s_mov_b32 s39, 0x00020000
    buffer_load_dwordx4 v6, s[36:39], s77 offen lds
    s_cmp_ge_u32 s3, 2
    s_cbranch_scc1 K2_X2
    s_add_u32 m0, s78, 72704
    s_add_u32 s77, s77, 8192
    buffer_load_dwordx4 v6, s[36:39], s77 offen lds
K2_X2:
    s_mov_b32 m0, s64
    s_add_u32 s40, s22, 0x800000
    s_addc_u32 s41, s23, 0
    s_mov_b32 s42, 0x24000
    s_mov_b32 s43, 0x00020000
    buffer_load_dwordx4 v4, s[40:43], s11 offen offset:0 lds
    buffer_load_dwordx4 v4, s[40:43], s11 offen offset:1024 lds
    buffer_load_dwordx4 v4, s[40:43], s11 offen offset:2048 lds
    buffer_load_dwordx4 v4, s[40:43], s11 offen offset:3072 lds
    s_mov_b32 s28, s22
    s_mov_b32 s29, s23
    s_mov_b32 s30, 0x1d4c00
    s_mov_b32 s31, 0x00020000
    s_mov_b32 s59, 0
    s_mov_b32 s60, 128
    s_mov_b32 s65, 1
    s_mov_b32 s66, 1
    s_lshl_b32 s6, s3, 9
    s_add_u32 s6, s6, 60416
    v_and_b32 v7, 3, v0
    s_movk_i32 s76, 1280
    v_mad_u32_u24 v185, v3, s76, v7
    v_mul_u32_u24 v185, 12, v185
    v_xor_b32 v162, 3, v7
    v_lshlrev_b32 v162, 16, v162
    v_lshl_add_u32 v160, v1, 2, s6
    v_add_u32 v161, 64, v1
    v_and_b32 v2, 31, v1
    v_lshrrev_b32 v5, 5, v1
    s_lshl_b32 s76, s52, 4
    v_add_u32 v208, 12, v2
    v_lshrrev_b32 v208, 5, v208
    v_mad_i32_i24 v208, v208, -4, v2
    v_add_u32 v208, -4, v208
    v_min_u32 v208, 23, v208
    v_add_u32 v208, s76, v208
    v_and_b32 v7, 15, v208
    v_xor_b32 v7, v7, v5
    v_lshlrev_b32 v7, 4, v7
    v_lshl_add_u32 v208, v208, 8, v7
    v_add_u32 v208, 64512, v208
    v_xor_b32 v209, 32, v208
    v_xor_b32 v210, 64, v208
    v_xor_b32 v211, 96, v208
    v_xor_b32 v212, 128, v208
    v_xor_b32 v213, 160, v208
    v_xor_b32 v214, 192, v208
    v_xor_b32 v215, 224, v208
    s_lshl_b32 s76, s53, 14
    s_add_u32 s76, s76, 98304
    v_add_u32 v3, s76, v4
    s_add_u32 s32, s22, 0x300000
    s_addc_u32 s33, s23, 0
    s_or_b32 s33, s33, 0x2000000
    s_mov_b32 s34, 0x2710
    s_mov_b32 s35, 0x00020000
    s_mov_b32 s44, s20
    s_mov_b32 s45, s21
    s_mov_b32 s46, 0x271000
    s_mov_b32 s47, 0x00020000
    s_mov_b32 s68, 0
    s_mul_i32 s69, s52, 28288
    s_mul_i32 s70, s52, 1664
    s_add_u32 s70, s70, 57088
    s_lshl_b32 s76, s54, 2
    s_sub_u32 s7, 56576, s76
    s_mov_b32 s8, 0xfffc8c00
    s_mov_b32 s56, 57088
    s_mul_i32 s9, s3, 9216
    s_add_u32 s9, s9, 65536
    s_setprio 3
    s_waitcnt vmcnt(5)
    v_add_u32 v7, v184, v162
    v_and_b32 v6, 0xffff, v184
    v_lshrrev_b32 v184, 18, v7
    v_mad_u32_u24 v185, v6, 12, v185
    v_add_u32 v157, 48, v185
    v_add_u32_dpp v183, v184, v184 row_shr:1 row_mask:0xf bank_mask:0xf bound_ctrl:0
    v_add_u32 v158, 96, v185
    v_add_u32 v159, 144, v185
    v_add_u32_dpp v183, v183, v183 row_shr:2 row_mask:0xf bank_mask:0xf bound_ctrl:0
    v_cmp_lt_u32 vcc, 4, v184
    s_nop 0
    v_add_u32_dpp v183, v183, v183 row_shr:4 row_mask:0xf bank_mask:0xf bound_ctrl:0
    s_nop 1
    v_add_u32_dpp v183, v183, v183 row_shr:8 row_mask:0xf bank_mask:0xf bound_ctrl:0
    s_nop 1
    v_add_u32_dpp v183, v183, v183 row_bcast:15 row_mask:0xa bank_mask:0xf
    s_nop 1
    v_add_u32_dpp v183, v183, v183 row_bcast:31 row_mask:0xc bank_mask:0xf
    s_cbranch_vccnz K2_GEN0
    v_readlane_b32 s58, v183, 63
    v_sub_u32 v183, v183, v184
    v_lshl_add_u32 v6, v183, 2, s6
    s_cmp_gt_u32 s58, 128
    s_cbranch_scc1 K2_GEN
    s_mov_b32 s76, s58
    v_cmpx_lt_u32 vcc, 0, v184
    ds_write_b32 v6, v185 offset:0
    v_cmpx_lt_u32 vcc, 1, v184
    ds_write_b32 v6, v157 offset:4
    v_cmpx_lt_u32 vcc, 2, v184
    ds_write_b32 v6, v158 offset:8
    v_cmpx_lt_u32 vcc, 3, v184
    ds_write_b32 v6, v159 offset:12
K2_LISTED:
    s_mov_b64 exec, -1
    ds_read_b32 v156, v160
    ds_read_b32 v157, v160 offset:256
    v_cmp_gt_u32 s[72:73], s76, v1
    v_cmp_gt_u32 s[74:75], s76, v161
    s_waitcnt lgkmcnt(1)
    buffer_load_dwordx3 v[140:142], v156, s[28:31], 0 offen
    s_waitcnt lgkmcnt(0)
    buffer_load_dwordx3 v[144:146], v157, s[28:31], 0 offen
    s_setprio 0
    s_cmp_eq_u32 s65, 0
    s_cbranch_scc1 K2_NF2
    s_lshl_b32 s77, s3, 11
    s_add_u32 m0, s77, 74752
    s_add_u32 s76, s11, 4096
    buffer_load_dwordx4 v4, s[40:43], s76 offen offset:0 lds
    buffer_load_dwordx4 v4, s[40:43], s76 offen offset:1024 lds
    s_add_u32 m0, s64, 2048
    s_nop 0
    buffer_load_dwordx4 v4, s[40:43], s76 offen offset:2048 lds
    buffer_load_dwordx4 v4, s[40:43], s76 offen offset:3072 lds
K2_NF2:
    v_mov_b32 v132, 10000
    s_lshl_b32 m0, s3, 8
    s_min_u32 s76, s3, 4
    ds_write_addtid_b32 v132 offset:57088
    s_lshl_b32 m0, s76, 8
    s_nop 0
    ds_write_addtid_b32 v132 offset:59136
    s_cmp_eq_u32 s65, 0
    s_cbranch_scc1 K2_NF3
    v_and_b32 v168, 7, v1
    v_lshrrev_b32 v7, 4, v1
    v_xor_b32 v7, v168, v7
    v_lshlrev_b32 v7, 4, v7
    s_lshl_b32 s76, s53, 7
    v_add_u32 v169, s76, v7
    v_xor_b32 v171, 64, v169
    v_mov_b32 v173, v169
    v_mov_b32 v175, v171
    v_mov_b32 v182, 0
    s_lshl_b32 s76, s53, 11
    s_add_u32 s76, s76, 139264
    s_waitcnt vmcnt(6) lgkmcnt(0)
    s_barrier
    ds_read_b128 v[224:227], v3 offset:0
    ds_read_b128 v[240:243], v3 offset:8192
    ds_read_b128 v[228:231], v3 offset:1024
    ds_read_b128 v[244:247], v3 offset:9216
    ds_read_b128 v[232:235], v3 offset:2048
    ds_read_b128 v[248:251], v3 offset:10240
    ds_read_b128 v[236:239], v3 offset:3072
    ds_read_b128 v[252:255], v3 offset:11264
    buffer_load_dwordx4 v[112:115], v4, s[40:43], s76 offen offset:0
    buffer_load_dwordx4 v[116:119], v4, s[40:43], s76 offen offset:1024
    s_cmp_lg_u32 s3, 3
    s_cbranch_scc1 K2_NMX
    s_add_u32 s48, s22, 0x830000
    s_addc_u32 s49, s23, 0
    s_mov_b32 s50, 0x13a0
    s_mov_b32 s51, 0x00020000
    s_movk_i32 s76, 0x1000
    buffer_load_dwordx4 v[16:19], v4, s[48:51], 0 offen offset:0
    buffer_load_dwordx4 v[20:23], v4, s[48:51], 0 offen offset:1024
    buffer_load_dwordx4 v[24:27], v4, s[48:51], 0 offen offset:2048
    buffer_load_dwordx4 v[28:31], v4, s[48:51], 0 offen offset:3072
    buffer_load_dwordx4 v[120:123], v4, s[48:51], s76 offen offset:0
    s_add_u32 s48, s22, 0x831400
    s_addc_u32 s49, s23, 0
    s_mov_b32 s50, 0x9c4
    s_mov_b32 s51, 0x00020000
    buffer_load_dwordx4 v[124:127], v4, s[48:51], 0 offen offset:0
    buffer_load_dwordx4 v[216:219], v4, s[48:51], 0 offen offset:1024
    buffer_load_dwordx4 v[220:223], v4, s[48:51], 0 offen offset:2048
    s_waitcnt vmcnt(14)
    s_branch K2_J3
K2_NMX:
    s_waitcnt vmcnt(6)
K2_J3:
    s_setprio 3
    v_mov_b32 v6, 1
    v_lshrrev_b32 v148, 14, v142
    v_lshrrev_b32 v149, 14, v146
    v_lshl_add_u32 v148, v148, 2, s7
    v_lshl_add_u32 v149, v149, 2, s7
    s_mov_b64 exec, s[72:73]
    ds_add_rtn_u32 v150, v148, v6
    s_mov_b64 exec, s[74:75]
    ds_add_rtn_u32 v151, v149, v6
    s_mov_b64 exec, -1
    v_mov_b32 v7, 56832
    v_mov_b32 v132, s58
    v_lshlrev_b32 v133, 2, v1
    s_mov_b64 exec, 1
    ds_max_u32 v7, v132
    s_mov_b64 exec, -1
    v_add_u32 v6, 56576, v133
    s_waitcnt lgkmcnt(0)
    s_barrier
    ds_read_b32 v133, v6
    ds_read_b32 v132, v7
    buffer_load_dwordx4 v[188:191], v4, s[40:43], s9 offen offset:0
    buffer_load_dwordx4 v[192:195], v4, s[40:43], s9 offen offset:1024
    v_and_b32 v142, 0x3fff, v142
    v_and_b32 v146, 0x3fff, v146
    s_waitcnt lgkmcnt(1)
    v_add_u32 v7, 1, v133
    v_and_b32 v7, -2, v7
    v_mov_b32 v6, v7
    v_cvt_f32_u32 v133, v133
    v_add_u32_dpp v7, v7, v7 row_shr:1 row_mask:0xf bank_mask:0xf bound_ctrl:0
    v_mov_b32 v134, 1664
    v_mov_b32 v135, 2176
    v_add_u32_dpp v7, v7, v7 row_shr:2 row_mask:0xf bank_mask:0xf bound_ctrl:0
    v_add_u32 v180, s69, v4
    v_lshrrev_b32 v181, 3, v1
    v_add_u32_dpp v7, v7, v7 row_shr:4 row_mask:0xf bank_mask:0xf bound_ctrl:0
    v_lshl_add_u32 v181, v181, 2, s70
    s_waitcnt lgkmcnt(0)
    v_add_u32_dpp v7, v7, v7 row_shr:8 row_mask:0xf bank_mask:0xf bound_ctrl:0
    v_readfirstlane_b32 s78, v132
    v_mov_b32 v132, 0x3f80
    v_add_u32_dpp v7, v7, v7 row_bcast:15 row_mask:0xa bank_mask:0xf
    v_mov_b32 v131, 2048
    s_nop 0
    v_add_u32_dpp v7, v7, v7 row_bcast:31 row_mask:0xc bank_mask:0xf
    s_cmp_eq_u32 s60, 48
    v_readlane_b32 s77, v7, 63
    v_sub_u32 v6, v7, v6
    s_cbranch_scc1 K2_FIX
    s_add_u32 s76, s77, 63
    s_lshr_b32 s76, s76, 6
    s_lshl_b32 s76, s76, 5
K2_CUT:
    s_sub_u32 s17, s77, s76
    v_cmp_ge_u32 vcc, s76, v7
    v_cmp_le_i32 s[12:13], s17, v7
    s_and_b32 s17, vcc_lo, 0xff8000
    s_and_b32 s17, s17, s12
    s_cbranch_scc0 K2_CUT2
    s_flbit_i32_b32 s17, s17
    s_sub_u32 s17, 31, s17
K2_CUTD:
    v_readlane_b32 s76, v7, s17
    s_add_u32 s17, s17, 1
    s_lshl_b64 exec, -1, s17
    s_sub_u32 s12, 416, s76
    v_add_u32 v6, s12, v6
    s_mov_b64 exec, -1
    ds_bpermute_b32 v154, v148, v6
    ds_bpermute_b32 v155, v149, v6
    s_sub_u32 s77, s77, s76
    buffer_load_dwordx4 v[196:199], v4, s[40:43], s9 offen offset:2048
    buffer_load_dwordx4 v[200:203], v4, s[40:43], s9 offen offset:3072
    s_add_u32 s79, s9, 4096
    buffer_load_dwordx4 v[204:207], v4, s[40:43], s79 offen offset:0
    s_mov_b32 s65, 0
    s_cmp_eq_u32 s52, 0
    s_cselect_b32 s62, s76, s77
    s_add_u32 s62, s62, 31
    s_lshr_b32 s62, s62, 5
    s_add_u32 s16, s76, 31
    s_lshr_b32 s16, s16, 5
    s_sub_u32 s16, s62, s16
    s_max_i32 s16, s16, 0
    s_max_u32 s76, s76, s77
    s_cmp_gt_u32 s76, 416
    s_cselect_b32 s76, 0x7fffffff, s78
    s_cmp_gt_u32 s76, s60
    s_cbranch_scc1 K2_OV
K2_NOOV:
    s_lshl_b32 s76, s17, 2
    s_add_u32 s76, s76, 56576
    s_waitcnt lgkmcnt(1)
    v_add_u32 v154, v154, v150
    v_lshl_add_u32 v80, v154, 2, s56
    s_waitcnt lgkmcnt(0)
    v_add_u32 v155, v155, v151
    v_lshl_add_u32 v81, v155, 2, s56
    s_mov_b64 exec, s[72:73]
    ds_write_b32 v80, v142
    s_mov_b64 exec, s[74:75]
    ds_write_b32 v81, v146
    s_mov_b64 exec, -1
    v_add_f32 v182, v182, v133
    s_waitcnt vmcnt(5) lgkmcnt(0)
    s_barrier
    ds_read_b32 v168, v181 offset:0
    ds_read_b32 v170, v181 offset:32
    ds_read_b32 v172, v181 offset:64
    ds_read_b32 v174, v181 offset:96
    s_cmp_eq_u32 s66, 0
    s_cbranch_scc1 K2_NF4
    s_waitcnt lgkmcnt(0)
    s_add_u32 m0, s64, 0
    s_nop 0
    buffer_load_dwordx4 v[168:169], s[32:35], 0 idxen offen lds
    s_add_u32 m0, s64, 1024
    s_nop 0
    buffer_load_dwordx4 v[170:171], s[32:35], 0 idxen offen lds
    s_add_u32 m0, s64, 2048
    s_nop 0
    buffer_load_dwordx4 v[172:173], s[32:35], 0 idxen offen lds
    s_add_u32 m0, s64, 3072
    s_nop 0
    buffer_load_dwordx4 v[174:175], s[32:35], 0 idxen offen lds
    v_add_u32 v6, 20, v2
    v_lshrrev_b32 v6, 5, v6
    v_lshrrev_b32 v7, 2, v2
    v_add3_u32 v6, v6, v7, 1
    v_bfe_u32 v186, v6, 1, 1
    v_and_b32 v187, 1, v6
    v_lshl_add_u32 v186, v187, 1, v186
    v_lshlrev_b32 v186, 2, v186
    v_lshrrev_b32 v6, 2, v6
    v_lshl_add_u32 v187, v6, 4, v186
    v_and_b32 v7, 3, v2
    v_lshlrev_b32 v187, v187, v7
    v_or_b32 v187, 0x40004, v187
    v_lshl_add_u32 v186, v6, 9, v186
    v_lshlrev_b32 v163, 2, v2
    v_lshl_add_u32 v163, v5, 1, v163
    v_cmpx_le_u32 vcc, s76, v148
    v_add_u32 v148, -64, v148
    s_mov_b64 exec, -1
    v_cmpx_le_u32 vcc, s76, v149
    v_add_u32 v149, -64, v149
    s_mov_b64 exec, -1
    ds_bpermute_b32 v166, v148, v186
    ds_bpermute_b32 v164, v148, v187
    ds_bpermute_b32 v167, v149, v186
    ds_bpermute_b32 v165, v149, v187
    v_bfe_u32 v6, v1, 1, 3
    v_xor_b32 v6, v6, v5
    v_lshlrev_b32 v6, 4, v6
    v_lshl_add_u32 v6, v2, 7, v6
    v_add_u32 v176, s64, v6
    v_xor_b32 v177, 32, v176
    v_xor_b32 v178, 64, v176
    v_xor_b32 v179, 96, v176
    v_and_b32 v7, 1, v1
    v_lshlrev_b32 v7, 4, v7
    v_mov_b32 v6, 0x3f80
    v_lshlrev_b32 v7, v7, v6
    v_mov_b32 v8, 0
    v_mov_b32 v12, 0
    s_mov_b32 exec_lo, 0x3
    s_mov_b32 exec_hi, 0x300
    v_mov_b32 v8, v7
    s_mov_b32 exec_lo, 0x30000
    s_mov_b32 exec_hi, 0x3000000
    v_mov_b32 v12, v7
    s_mov_b64 exec, -1
    s_lshl_b32 s76, s53, 12
    v_mov_b32_dpp v9, v8 row_shr:2 row_mask:0xf bank_mask:0xf bound_ctrl:0
    v_mov_b32_dpp v13, v12 row_shr:2 row_mask:0xf bank_mask:0xf bound_ctrl:0
    s_add_u32 s76, s76, 74752
    v_mov_b32_dpp v10, v9 row_shr:2 row_mask:0xf bank_mask:0xf bound_ctrl:0
    v_mov_b32_dpp v14, v13 row_shr:2 row_mask:0xf bank_mask:0xf bound_ctrl:0
    v_add_u32 v2, s76, v4
    v_mov_b32_dpp v11, v10 row_shr:2 row_mask:0xf bank_mask:0xf bound_ctrl:0
    v_mov_b32_dpp v15, v14 row_shr:2 row_mask:0xf bank_mask:0xf bound_ctrl:0
    v_add_u32 v5, s69, v163
    v_lshl_add_u32 v152, v148, 2, s8
    v_lshl_add_u32 v153, v149, 2, s8
    s_waitcnt lgkmcnt(0)
    v_lshrrev_b32 v80, 5, v154
    v_mul_u32_u24 v82, v80, v134
    v_mad_u32_u24 v83, v80, v135, v152
    v_lshl_add_u32 v82, v154, 4, v82
    v_mul_u32_u24 v86, v80, v131
    v_and_b32 v84, 4, v154
    v_lshrrev_b32 v85, 1, v154
    v_lshl_add_u32 v83, v84, 7, v83
    v_add_u32 v84, v166, v82
    v_and_or_b32 v83, v85, 12, v83
    v_lshl_add_u32 v86, v154, 2, v86
    v_and_or_b32 v83, v154, 2, v83
    s_mov_b64 exec, s[72:73]
    ds_write2_b32 v82, v140, v141 offset0:0 offset1:128
    ds_write_b16 v84, v132
    ds_write_b32 v86, v164 offset:1024
    ds_write_b16 v83, v132 offset:1152
    s_mov_b64 exec, -1
    v_lshrrev_b32 v80, 5, v155
    v_mul_u32_u24 v82, v80, v134
    v_mad_u32_u24 v83, v80, v135, v153
    v_lshl_add_u32 v82, v155, 4, v82
    v_mul_u32_u24 v86, v80, v131
    v_and_b32 v84, 4, v155
    v_lshrrev_b32 v85, 1, v155
    v_lshl_add_u32 v83, v84, 7, v83
    v_add_u32 v84, v167, v82
    v_and_or_b32 v83, v85, 12, v83
    v_lshl_add_u32 v86, v155, 2, v86
    v_and_or_b32 v83, v155, 2, v83
    s_mov_b64 exec, s[74:75]
    ds_write2_b32 v82, v144, v145 offset0:0 offset1:128
    ds_write_b16 v84, v132
    ds_write_b32 v86, v165 offset:1024
    ds_write_b16 v83, v132 offset:1152
    s_mov_b64 exec, -1
    ds_read_b128 v[64:67], v208
    ds_read_b128 v[68:71], v209
    ds_read_b32 v168, v181 offset:128
    ds_read_b32 v170, v181 offset:160
    ds_read_b32 v172, v181 offset:192
    ds_read_b32 v174, v181 offset:224
    ds_read_b128 v[136:139], v2 offset:0
    ds_read_b128 v[144:147], v2 offset:2048
    ds_read_b128 v[140:143], v2 offset:1024
    ds_read_b128 v[148:151], v2 offset:3072
    ds_read_b128 v[96:99], v3 offset:4096
    ds_read_b128 v[104:107], v3 offset:12288
    ds_read_b128 v[100:103], v3 offset:5120
    ds_read_b128 v[108:111], v3 offset:13312
    s_setprio 0
    s_waitcnt lgkmcnt(13)
    v_mfma_f32_32x32x16_bf16 v[32:47], v[64:67], v[224:227], 0
    v_mfma_f32_32x32x16_bf16 v[48:63], v[64:67], v[240:243], 0
    s_waitcnt lgkmcnt(12)
    v_mfma_f32_32x32x16_bf16 v[32:47], v[68:71], v[228:231], v[32:47]
    v_mfma_f32_32x32x16_bf16 v[48:63], v[68:71], v[244:247], v[48:63]
    ds_read_b128 v[72:75], v210
    ds_read_b128 v[76:79], v211
    ds_read_b128 v[80:83], v212
    ds_read_b128 v[84:87], v213
    ds_read_b128 v[88:91], v214
    ds_read_b128 v[92:95], v215
    s_cmp_lg_u32 s3, 3
    s_cbranch_scc1 K2_NMX2
    v_max3_u32 v16, v16, v17, v18
    v_max3_u32 v16, v16, v19, v20
    v_max3_u32 v16, v16, v21, v22
    v_max3_u32 v16, v16, v23, v24
    v_max3_u32 v16, v16, v25, v26
    v_max3_u32 v16, v16, v27, v28
    v_max3_u32 v16, v16, v29, v30
    v_max3_u32 v16, v16, v31, v120
    v_max3_u32 v16, v16, v121, v122
    v_max_u32 v128, v16, v123
    v_max3_u32 v124, v124, v125, v126
    v_max3_u32 v124, v124, v127, v216
    v_max3_u32 v124, v124, v217, v218
    v_max3_u32 v124, v124, v219, v220
    v_max3_u32 v124, v124, v221, v222
    v_max_u32 v129, v124, v223
    s_nop 0
    v_max_u32_dpp v128, v128, v128 row_shr:1 row_mask:0xf bank_mask:0xf bound_ctrl:0
    v_max_u32_dpp v129, v129, v129 row_shr:1 row_mask:0xf bank_mask:0xf bound_ctrl:0
    s_nop 0
    v_max_u32_dpp v128, v128, v128 row_shr:2 row_mask:0xf bank_mask:0xf bound_ctrl:0
    v_max_u32_dpp v129, v129, v129 row_shr:2 row_mask:0xf bank_mask:0xf bound_ctrl:0
    s_nop 0
    v_max_u32_dpp v128, v128, v128 row_shr:4 row_mask:0xf bank_mask:0xf bound_ctrl:0
    v_max_u32_dpp v129, v129, v129 row_shr:4 row_mask:0xf bank_mask:0xf bound_ctrl:0
    s_nop 0
    v_max_u32_dpp v128, v128, v128 row_shr:8 row_mask:0xf bank_mask:0xf bound_ctrl:0
    v_max_u32_dpp v129, v129, v129 row_shr:8 row_mask:0xf bank_mask:0xf bound_ctrl:0
    s_nop 0
    v_max_u32_dpp v128, v128, v128 row_bcast:15 row_mask:0xa bank_mask:0xf
    v_max_u32_dpp v129, v129, v129 row_bcast:15 row_mask:0xa bank_mask:0xf
    s_nop 0
    v_max_u32_dpp v128, v128, v128 row_bcast:31 row_mask:0xc bank_mask:0xf
    v_max_u32_dpp v129, v129, v129 row_bcast:31 row_mask:0xc bank_mask:0xf
    v_mov_b32 v7, 56836
    s_mov_b32 exec_lo, 0
    s_mov_b32 exec_hi, 0x80000000
    ds_write2_b32 v7, v128, v129 offset0:0 offset1:1
    s_mov_b64 exec, -1
    s_waitcnt lgkmcnt(0)
K2_NMX2:
    v_mov_b32 v7, 56836
    s_waitcnt lgkmcnt(6)
    s_barrier
    s_add_u32 m0, s64, 4096
    s_nop 0
    buffer_load_dwordx4 v[168:169], s[32:35], 0 idxen offen lds
    s_add_u32 m0, s64, 5120
    s_nop 0
    buffer_load_dwordx4 v[170:171], s[32:35], 0 idxen offen lds
    s_add_u32 m0, s64, 6144
    s_nop 0
    buffer_load_dwordx4 v[172:173], s[32:35], 0 idxen offen lds
    s_add_u32 m0, s64, 7168
    s_nop 0
    buffer_load_dwordx4 v[174:175], s[32:35], 0 idxen offen lds
    ds_read2_b32 v[132:133], v7 offset0:0 offset1:1
    s_waitcnt lgkmcnt(6)
    v_mfma_f32_32x32x16_bf16 v[32:47], v[72:75], v[232:235], v[32:47]
    v_mfma_f32_32x32x16_bf16 v[48:63], v[72:75], v[248:251], v[48:63]
    s_waitcnt lgkmcnt(5)
    v_mfma_f32_32x32x16_bf16 v[32:47], v[76:79], v[236:239], v[32:47]
    v_mfma_f32_32x32x16_bf16 v[48:63], v[76:79], v[252:255], v[48:63]
    s_waitcnt lgkmcnt(4)
    v_mfma_f32_32x32x16_bf16 v[32:47], v[80:83], v[136:139], v[32:47]
    v_mfma_f32_32x32x16_bf16 v[48:63], v[80:83], v[144:147], v[48:63]
    s_waitcnt lgkmcnt(3)
    v_mfma_f32_32x32x16_bf16 v[32:47], v[84:87], v[140:143], v[32:47]
    v_mfma_f32_32x32x16_bf16 v[48:63], v[84:87], v[148:151], v[48:63]
    s_waitcnt lgkmcnt(2)
    v_mfma_f32_32x32x16_bf16 v[32:47], v[88:91], v[96:99], v[32:47]
    v_mfma_f32_32x32x16_bf16 v[48:63], v[88:91], v[104:107], v[48:63]
    s_waitcnt lgkmcnt(1)
    v_mfma_f32_32x32x16_bf16 v[32:47], v[92:95], v[100:103], v[32:47]
    v_mfma_f32_32x32x16_bf16 v[48:63], v[92:95], v[108:111], v[48:63]
    s_mov_b32 s67, 0
    s_mov_b32 s66, 0
    s_mov_b32 s61, 1
    s_nop 7
    v_max_f32 v6, |v32|, |v33|
    v_max3_f32 v6, |v34|, |v35|, v6
    v_max3_f32 v6, |v36|, |v37|, v6
    v_max3_f32 v6, |v38|, |v39|, v6
    v_max3_f32 v6, |v40|, |v41|, v6
    v_max3_f32 v6, |v42|, |v43|, v6
    v_max3_f32 v6, |v44|, |v45|, v6
    v_max3_f32 v6, |v46|, |v47|, v6
    v_cvt_pk_bf16_f32 v16, v32, v33
    v_cvt_pk_bf16_f32 v17, v34, v35
    v_cvt_pk_bf16_f32 v18, v36, v37
    v_cvt_pk_bf16_f32 v19, v38, v39
    v_cvt_pk_bf16_f32 v20, v40, v41
    v_cvt_pk_bf16_f32 v21, v42, v43
    v_cvt_pk_bf16_f32 v22, v44, v45
    v_cvt_pk_bf16_f32 v23, v46, v47
    s_mov_b32 exec_hi, 0
    v_mov_b32 v16, v112
    v_mov_b32 v20, v113
    s_mov_b32 exec_hi, -1
    s_waitcnt lgkmcnt(0)
    v_fma_f32 v7, v133, v115, v132
    v_add_f32 v6, v7, v6
    v_cmp_nge_f32 vcc, 0x42700000, v6
    s_cmp_lg_u64 vcc, 0
    s_cselect_b32 s67, 1, s67
    v_max_f32 v6, |v48|, |v49|
    v_max3_f32 v6, |v50|, |v51|, v6
    v_max3_f32 v6, |v52|, |v53|, v6
    v_max3_f32 v6, |v54|, |v55|, v6
    v_max3_f32 v6, |v56|, |v57|, v6
    v_max3_f32 v6, |v58|, |v59|, v6
    v_max3_f32 v6, |v60|, |v61|, v6
    v_max3_f32 v6, |v62|, |v63|, v6
    v_cvt_pk_bf16_f32 v24, v48, v49
    v_cvt_pk_bf16_f32 v25, v50, v51
    v_cvt_pk_bf16_f32 v26, v52, v53
    v_cvt_pk_bf16_f32 v27, v54, v55
    v_cvt_pk_bf16_f32 v28, v56, v57
    v_cvt_pk_bf16_f32 v29, v58, v59
    v_cvt_pk_bf16_f32 v30, v60, v61
    v_cvt_pk_bf16_f32 v31, v62, v63
    s_mov_b32 exec_hi, 0
    v_mov_b32 v24, v116
    v_mov_b32 v28, v117
    s_mov_b32 exec_hi, -1
    v_fma_f32 v7, v133, v119, v132
    v_add_f32 v6, v7, v6
    v_cmp_nge_f32 vcc, 0x42700000, v6
    s_cmp_lg_u64 vcc, 0
    s_cselect_b32 s67, 1, s67
    s_cmp_lt_u32 s62, 2
    s_cselect_b32 s76, 1, s67
    s_cmp_eq_u32 s60, 48
    s_cbranch_scc1 K2_SLOW0
    s_mov_b32 s63, s62
    s_cmp_lg_u32 s76, 0
    s_cbranch_scc1 K2_SLOW
    ds_read_b128 v[156:159], v180 offset:0
    ds_read_u16 v160, v5 offset:1024
    ds_read_b32 v168, v181 offset:256
    ds_read_b32 v170, v181 offset:288
    ds_read_b32 v172, v181 offset:320
    ds_read_b32 v174, v181 offset:352
    s_waitcnt vmcnt(4)
    ds_read_b128 v[140:143], v176 offset:0
    ds_read_b128 v[144:147], v177 offset:0
    ds_read_b128 v[148:151], v178 offset:0
    ds_read_b128 v[152:155], v179 offset:0
    s_waitcnt lgkmcnt(0)
    v_mfma_f32_32x32x16_bf16 v[64:79], v[140:143], v[8:11], 0
    v_mfma_f32_32x32x16_bf16 v[64:79], v[144:147], v[12:15], v[64:79]
    v_smfmac_f32_32x32x32_bf16 v[64:79], v[156:159], v[16:23], v160
    s_add_u32 m0, s64, 0
    s_nop 0
    buffer_load_dwordx4 v[168:169], s[32:35], 0 idxen offen lds
    s_add_u32 m0, s64, 1024
    s_nop 0
    buffer_load_dwordx4 v[170:171], s[32:35], 0 idxen offen lds
    s_add_u32 m0, s64, 2048
    s_nop 0
    buffer_load_dwordx4 v[172:173], s[32:35], 0 idxen offen lds
    s_add_u32 m0, s64, 3072
    s_nop 0
    buffer_load_dwordx4 v[174:175], s[32:35], 0 idxen offen lds
    s_cmp_eq_u32 s52, 0
    s_cbranch_scc1 K2_FB
    s_nop 1
    s_setprio 2
    v_mfma_f32_32x32x16_bf16 v[80:95], v[148:151], v[8:11], 0
    v_exp_f32 v96, v64
    v_exp_f32 v97, v65
    v_exp_f32 v98, v66
    v_exp_f32 v99, v67
    v_exp_f32 v100, v68
    v_mfma_f32_32x32x16_bf16 v[80:95], v[152:155], v[12:15], v[80:95]
    v_exp_f32 v101, v69
    v_exp_f32 v102, v70
    v_exp_f32 v103, v71
    v_exp_f32 v104, v72
    v_exp_f32 v105, v73
    v_smfmac_f32_32x32x32_bf16 v[80:95], v[156:159], v[24:31], v160
    v_exp_f32 v106, v74
    v_exp_f32 v107, v75
    v_exp_f32 v108, v76
    v_exp_f32 v109, v77
    v_exp_f32 v110, v78
    v_exp_f32 v111, v79
    s_setprio 0
    s_waitcnt vmcnt(4)
    ds_read_b128 v[140:143], v176 offset:4096
    ds_read_b128 v[144:147], v177 offset:4096
    ds_read_b128 v[156:159], v180 offset:2176
    ds_read_u16 v160, v5 offset:3200
    ds_read_b128 v[148:151], v178 offset:4096
    ds_read_b128 v[152:155], v179 offset:4096
    ds_read_b32 v168, v181 offset:384
    ds_read_b32 v170, v181 offset:416
    ds_read_b32 v172, v181 offset:448
    ds_read_b32 v174, v181 offset:480
    ds_read_b128 v[164:167], v180 offset:1152
    s_waitcnt lgkmcnt(0)
    v_add_f32 v97, 1.0, v97
    v_add_f32 v99, 1.0, v99
    v_add_f32 v101, 1.0, v101
    v_add_f32 v103, 1.0, v103
    v_add_f32 v105, 1.0, v105
    v_add_f32 v107, 1.0, v107
    v_add_f32 v109, 1.0, v109
    v_add_f32 v111, 1.0, v111
    v_fma_f32 v120, v65, v96, v65
    v_fma_f32 v121, v67, v98, v67
    v_fma_f32 v122, v69, v100, v69
    v_fma_f32 v123, v71, v102, v71
    v_fma_f32 v124, v73, v104, v73
    v_fma_f32 v125, v75, v106, v75
    v_fma_f32 v126, v77, v108, v77
    v_fma_f32 v127, v79, v110, v79
    v_fma_f32 v112, v96, v97, v97
    v_fma_f32 v113, v98, v99, v99
    v_fma_f32 v114, v100, v101, v101
    v_fma_f32 v115, v102, v103, v103
    v_fma_f32 v116, v104, v105, v105
    v_fma_f32 v117, v106, v107, v107
    v_fma_f32 v118, v108, v109, v109
    v_fma_f32 v119, v110, v111, v111
    v_fmac_f32 v120, v64, v97
    v_fmac_f32 v121, v66, v99
    v_fmac_f32 v122, v68, v101
    v_fmac_f32 v123, v70, v103
    v_fmac_f32 v124, v72, v105
    v_fmac_f32 v125, v74, v107
    v_fmac_f32 v126, v76, v109
    v_fmac_f32 v127, v78, v111
    s_setprio 2
    v_mfma_f32_32x32x16_bf16 v[64:79], v[140:143], v[8:11], 0
    v_exp_f32 v96, v80
    v_exp_f32 v97, v81
    v_exp_f32 v98, v82
    v_exp_f32 v99, v83
    v_exp_f32 v100, v84
    v_exp_f32 v101, v85
    v_mfma_f32_32x32x16_bf16 v[64:79], v[144:147], v[12:15], v[64:79]
    v_exp_f32 v102, v86
    v_exp_f32 v103, v87
    v_exp_f32 v104, v88
    v_exp_f32 v105, v89
    v_exp_f32 v106, v90
    v_exp_f32 v107, v91
    v_smfmac_f32_32x32x32_bf16 v[64:79], v[156:159], v[16:23], v160
    v_exp_f32 v108, v92
    v_exp_f32 v109, v93
    v_exp_f32 v110, v94
    v_exp_f32 v111, v95
    v_rcp_f32 v112, v112
    v_rcp_f32 v113, v113
    v_rcp_f32 v114, v114
    v_rcp_f32 v115, v115
    v_rcp_f32 v116, v116
    v_rcp_f32 v117, v117
    v_rcp_f32 v118, v118
    v_rcp_f32 v119, v119
    s_setprio 0
    s_add_u32 m0, s64, 4096
    s_nop 0
    buffer_load_dwordx4 v[168:169], s[32:35], 0 idxen offen lds
    s_add_u32 m0, s64, 5120
    s_nop 0
    buffer_load_dwordx4 v[170:171], s[32:35], 0 idxen offen lds
    s_add_u32 m0, s64, 6144
    s_nop 0
    buffer_load_dwordx4 v[172:173], s[32:35], 0 idxen offen lds
    s_add_u32 m0, s64, 7168
    s_nop 0
    buffer_load_dwordx4 v[174:175], s[32:35], 0 idxen offen lds
    s_sub_u32 s63, s63, 1
    s_cmp_le_u32 s63, 0
    v_mul_f32 v128, v120, v112
    v_mul_f32 v129, v121, v113
    v_mul_f32 v130, v122, v114
    v_mul_f32 v131, v123, v115
    v_mul_f32 v132, v124, v116
    v_mul_f32 v133, v125, v117
    v_mul_f32 v134, v126, v118
    v_mul_f32 v135, v127, v119
    v_add_f32 v97, 1.0, v97
    v_add_f32 v99, 1.0, v99
    v_add_f32 v101, 1.0, v101
    v_add_f32 v103, 1.0, v103
    v_add_f32 v105, 1.0, v105
    v_add_f32 v107, 1.0, v107
    v_add_f32 v109, 1.0, v109
    v_add_f32 v111, 1.0, v111
    v_fma_f32 v120, v81, v96, v81
    v_fma_f32 v121, v83, v98, v83
    v_fma_f32 v122, v85, v100, v85
    v_fma_f32 v123, v87, v102, v87
    v_fma_f32 v124, v89, v104, v89
    v_fma_f32 v125, v91, v106, v91
    v_fma_f32 v126, v93, v108, v93
    v_fma_f32 v127, v95, v110, v95
    v_fma_f32 v112, v96, v97, v97
    v_fma_f32 v113, v98, v99, v99
    v_fma_f32 v114, v100, v101, v101
    v_fma_f32 v115, v102, v103, v103
    v_fma_f32 v116, v104, v105, v105
    v_fma_f32 v117, v106, v107, v107
    v_fma_f32 v118, v108, v109, v109
    v_fma_f32 v119, v110, v111, v111
    v_fmac_f32 v120, v80, v97
    v_fmac_f32 v121, v82, v99
    v_fmac_f32 v122, v84, v101
    v_fmac_f32 v123, v86, v103
    v_fmac_f32 v124, v88, v105
    v_fmac_f32 v125, v90, v107
    v_fmac_f32 v126, v92, v109
    v_fmac_f32 v127, v94, v111
    s_setprio 2
    v_mfma_f32_32x32x16_bf16 v[80:95], v[148:151], v[8:11], 0
    v_cvt_pk_bf16_f32 v136, v128, v129
    v_cvt_pk_bf16_f32 v137, v130, v131
    v_cvt_pk_bf16_f32 v138, v132, v133
    v_cvt_pk_bf16_f32 v139, v134, v135
    v_exp_f32 v96, v64
    v_exp_f32 v97, v65
    v_exp_f32 v98, v66
    v_mfma_f32_32x32x16_bf16 v[80:95], v[152:155], v[12:15], v[80:95]
    v_exp_f32 v99, v67
    v_exp_f32 v100, v68
    v_exp_f32 v101, v69
    v_exp_f32 v102, v70
    v_exp_f32 v103, v71
    v_exp_f32 v104, v72
    v_smfmac_f32_32x32x32_bf16 v[80:95], v[156:159], v[24:31], v160
    v_exp_f32 v105, v73
    v_exp_f32 v106, v74
    v_exp_f32 v107, v75
    v_exp_f32 v108, v76
    v_exp_f32 v109, v77
    v_exp_f32 v110, v78
    v_exp_f32 v111, v79
    v_mfma_f32_32x32x16_bf16 v[32:47], v[136:139], v[164:167], 0
    v_rcp_f32 v112, v112
    v_rcp_f32 v113, v113
    v_rcp_f32 v114, v114
    v_rcp_f32 v115, v115
    v_rcp_f32 v116, v116
    v_rcp_f32 v117, v117
    v_rcp_f32 v118, v118
    v_rcp_f32 v119, v119
    s_setprio 0
    s_waitcnt vmcnt(4)
    ds_read_b128 v[140:143], v176 offset:0
    ds_read_b128 v[144:147], v177 offset:0
    ds_read_b128 v[156:159], v180 offset:4352
    ds_read_u16 v160, v5 offset:5376
    ds_read_b128 v[148:151], v178 offset:0
    ds_read_b128 v[152:155], v179 offset:0
    ds_read_b32 v168, v181 offset:512
    ds_read_b32 v170, v181 offset:544
    ds_read_b32 v172, v181 offset:576
    ds_read_b32 v174, v181 offset:608
    ds_read_b128 v[224:227], v180 offset:3328
    s_waitcnt lgkmcnt(0)
    v_mul_f32 v128, v120, v112
    v_mul_f32 v129, v121, v113
    v_mul_f32 v130, v122, v114
    v_mul_f32 v131, v123, v115
    v_mul_f32 v132, v124, v116
    v_mul_f32 v133, v125, v117
    v_mul_f32 v134, v126, v118
    v_mul_f32 v135, v127, v119
    v_add_f32 v97, 1.0, v97
    v_add_f32 v99, 1.0, v99
    v_add_f32 v101, 1.0, v101
    v_add_f32 v103, 1.0, v103
    v_add_f32 v105, 1.0, v105
    v_add_f32 v107, 1.0, v107
    v_add_f32 v109, 1.0, v109
    v_add_f32 v111, 1.0, v111
    v_fma_f32 v120, v65, v96, v65
    v_fma_f32 v121, v67, v98, v67
    v_fma_f32 v122, v69, v100, v69
    v_fma_f32 v123, v71, v102, v71
    v_fma_f32 v124, v73, v104, v73
    v_fma_f32 v125, v75, v106, v75
    v_fma_f32 v126, v77, v108, v77
    v_fma_f32 v127, v79, v110, v79
    v_fma_f32 v112, v96, v97, v97
    v_fma_f32 v113, v98, v99, v99
    v_fma_f32 v114, v100, v101, v101
    v_fma_f32 v115, v102, v103, v103
    v_fma_f32 v116, v104, v105, v105
    v_fma_f32 v117, v106, v107, v107
    v_fma_f32 v118, v108, v109, v109
    v_fma_f32 v119, v110, v111, v111
    v_fmac_f32 v120, v64, v97
    v_fmac_f32 v121, v66, v99
    v_fmac_f32 v122, v68, v101
    v_fmac_f32 v123, v70, v103
    v_fmac_f32 v124, v72, v105
    v_fmac_f32 v125, v74, v107
    v_fmac_f32 v126, v76, v109
    v_fmac_f32 v127, v78, v111
    s_setprio 2
    v_mfma_f32_32x32x16_bf16 v[64:79], v[140:143], v[8:11], 0
    v_cvt_pk_bf16_f32 v136, v128, v129
    v_cvt_pk_bf16_f32 v137, v130, v131
    v_cvt_pk_bf16_f32 v138, v132, v133
    v_cvt_pk_bf16_f32 v139, v134, v135
    v_exp_f32 v96, v80
    v_exp_f32 v97, v81
    v_exp_f32 v98, v82
    v_mfma_f32_32x32x16_bf16 v[64:79], v[144:147], v[12:15], v[64:79]
    v_exp_f32 v99, v83
    v_exp_f32 v100, v84
    v_exp_f32 v101, v85
    v_exp_f32 v102, v86
    v_exp_f32 v103, v87
    v_exp_f32 v104, v88
    v_smfmac_f32_32x32x32_bf16 v[64:79], v[156:159], v[16:23], v160
    v_exp_f32 v105, v89
    v_exp_f32 v106, v90
    v_exp_f32 v107, v91
    v_exp_f32 v108, v92
    v_exp_f32 v109, v93
    v_exp_f32 v110, v94
    v_exp_f32 v111, v95
    v_mfma_f32_32x32x16_bf16 v[48:63], v[136:139], v[164:167], 0
    v_rcp_f32 v112, v112
    v_rcp_f32 v113, v113
    v_rcp_f32 v114, v114
    v_rcp_f32 v115, v115
    v_rcp_f32 v116, v116
    v_rcp_f32 v117, v117
    v_rcp_f32 v118, v118
    v_rcp_f32 v119, v119
    s_setprio 0
    s_add_u32 m0, s64, 0
    s_nop 0
    buffer_load_dwordx4 v[168:169], s[32:35], 0 idxen offen lds
    s_add_u32 m0, s64, 1024
    s_nop 0
    buffer_load_dwordx4 v[170:171], s[32:35], 0 idxen offen lds
    s_add_u32 m0, s64, 2048
    s_nop 0
    buffer_load_dwordx4 v[172:173], s[32:35], 0 idxen offen lds
    s_add_u32 m0, s64, 3072
    s_nop 0
    buffer_load_dwordx4 v[174:175], s[32:35], 0 idxen offen lds
    s_sub_u32 s63, s63, 1
    s_cmp_le_u32 s63, s16
    s_cbranch_scc1 K2A_EXIT1
.p2align 6
K2A_LOOP:
    v_add_u32 v180, 4352, v180
    v_add_u32 v5, 4352, v5
    v_add_u32 v181, 256, v181
    v_mul_f32 v128, v120, v112
    v_mul_f32 v129, v121, v113
    v_mul_f32 v130, v122, v114
    v_mul_f32 v131, v123, v115
    v_mul_f32 v132, v124, v116
    v_mul_f32 v133, v125, v117
    v_mul_f32 v134, v126, v118
    v_mul_f32 v135, v127, v119
    v_add_f32 v97, 1.0, v97
    v_add_f32 v99, 1.0, v99
    v_add_f32 v101, 1.0, v101
    v_add_f32 v103, 1.0, v103
    v_add_f32 v105, 1.0, v105
    v_add_f32 v107, 1.0, v107
    v_add_f32 v109, 1.0, v109
    v_add_f32 v111, 1.0, v111
    v_fma_f32 v120, v81, v96, v81
    v_fma_f32 v121, v83, v98, v83
    v_fma_f32 v122, v85, v100, v85
    v_fma_f32 v123, v87, v102, v87
    v_fma_f32 v124, v89, v104, v89
    v_fma_f32 v125, v91, v106, v91
    v_fma_f32 v126, v93, v108, v93
    v_fma_f32 v127, v95, v110, v95
    v_fma_f32 v112, v96, v97, v97
    v_fma_f32 v113, v98, v99, v99
    v_fma_f32 v114, v100, v101, v101
    v_fma_f32 v115, v102, v103, v103
    v_fma_f32 v116, v104, v105, v105
    v_fma_f32 v117, v106, v107, v107
    v_fma_f32 v118, v108, v109, v109
    v_fma_f32 v119, v110, v111, v111
    v_fmac_f32 v120, v80, v97
    v_fmac_f32 v121, v82, v99
    v_fmac_f32 v122, v84, v101
    v_fmac_f32 v123, v86, v103
    v_fmac_f32 v124, v88, v105
    v_fmac_f32 v125, v90, v107
    v_fmac_f32 v126, v92, v109
    v_fmac_f32 v127, v94, v111
    s_setprio 2
    v_mfma_f32_32x32x16_bf16 v[80:95], v[148:151], v[8:11], 0
    v_cvt_pk_bf16_f32 v136, v128, v129
    v_cvt_pk_bf16_f32 v137, v130, v131
    v_cvt_pk_bf16_f32 v138, v132, v133
    v_cvt_pk_bf16_f32 v139, v134, v135
    v_exp_f32 v96, v64
    v_exp_f32 v97, v65
    v_exp_f32 v98, v66
    v_mfma_f32_32x32x16_bf16 v[80:95], v[152:155], v[12:15], v[80:95]
    v_exp_f32 v99, v67
    v_exp_f32 v100, v68
    v_exp_f32 v101, v69
    v_exp_f32 v102, v70
    v_exp_f32 v103, v71
    v_exp_f32 v104, v72
    v_smfmac_f32_32x32x32_bf16 v[80:95], v[156:159], v[24:31], v160
    v_exp_f32 v105, v73
    v_exp_f32 v106, v74
    v_exp_f32 v107, v75
    v_exp_f32 v108, v76
    v_exp_f32 v109, v77
    v_exp_f32 v110, v78
    v_exp_f32 v111, v79
    v_mfma_f32_32x32x16_bf16 v[32:47], v[136:139], v[224:227], v[32:47]
    v_rcp_f32 v112, v112
    v_rcp_f32 v113, v113
    v_rcp_f32 v114, v114
    v_rcp_f32 v115, v115
    v_rcp_f32 v116, v116
    v_rcp_f32 v117, v117
    v_rcp_f32 v118, v118
    v_rcp_f32 v119, v119
    s_setprio 0
    s_waitcnt vmcnt(4)
    ds_read_b128 v[140:143], v176 offset:4096
    ds_read_b128 v[144:147], v177 offset:4096
    ds_read_b128 v[156:159], v180 offset:2176
    ds_read_u16 v160, v5 offset:3200
    ds_read_b128 v[148:151], v178 offset:4096
    ds_read_b128 v[152:155], v179 offset:4096
    ds_read_b32 v168, v181 offset:384
    ds_read_b32 v170, v181 offset:416
    ds_read_b32 v172, v181 offset:448
    ds_read_b32 v174, v181 offset:480
    ds_read_b128 v[164:167], v180 offset:1152
    s_waitcnt lgkmcnt(0)
    v_mul_f32 v128, v120, v112
    v_mul_f32 v129, v121, v113
    v_mul_f32 v130, v122, v114
    v_mul_f32 v131, v123, v115
    v_mul_f32 v132, v124, v116
    v_mul_f32 v133, v125, v117
    v_mul_f32 v134, v126, v118
    v_mul_f32 v135, v127, v119
    v_add_f32 v97, 1.0, v97
    v_add_f32 v99, 1.0, v99
    v_add_f32 v101, 1.0, v101
    v_add_f32 v103, 1.0, v103
    v_add_f32 v105, 1.0, v105
    v_add_f32 v107, 1.0, v107
    v_add_f32 v109, 1.0, v109
    v_add_f32 v111, 1.0, v111
    v_fma_f32 v120, v65, v96, v65
    v_fma_f32 v121, v67, v98, v67
    v_fma_f32 v122, v69, v100, v69
    v_fma_f32 v123, v71, v102, v71
    v_fma_f32 v124, v73, v104, v73
    v_fma_f32 v125, v75, v106, v75
    v_fma_f32 v126, v77, v108, v77
    v_fma_f32 v127, v79, v110, v79
    v_fma_f32 v112, v96, v97, v97
    v_fma_f32 v113, v98, v99, v99
    v_fma_f32 v114, v100, v101, v101
    v_fma_f32 v115, v102, v103, v103
    v_fma_f32 v116, v104, v105, v105
    v_fma_f32 v117, v106, v107, v107
    v_fma_f32 v118, v108, v109, v109
    v_fma_f32 v119, v110, v111, v111
    v_fmac_f32 v120, v64, v97
    v_fmac_f32 v121, v66, v99
    v_fmac_f32 v122, v68, v101
    v_fmac_f32 v123, v70, v103
    v_fmac_f32 v124, v72, v105
    v_fmac_f32 v125, v74, v107
    v_fmac_f32 v126, v76, v109
    v_fmac_f32 v127, v78, v111
    s_setprio 2
    v_mfma_f32_32x32x16_bf16 v[64:79], v[140:143], v[8:11], 0
    v_cvt_pk_bf16_f32 v136, v128, v129
    v_cvt_pk_bf16_f32 v137, v130, v131
    v_cvt_pk_bf16_f32 v138, v132, v133
    v_cvt_pk_bf16_f32 v139, v134, v135
    v_exp_f32 v96, v80
    v_exp_f32 v97, v81
    v_exp_f32 v98, v82
    v_mfma_f32_32x32x16_bf16 v[64:79], v[144:147], v[12:15], v[64:79]
    v_exp_f32 v99, v83
    v_exp_f32 v100, v84
    v_exp_f32 v101, v85
    v_exp_f32 v102, v86
    v_exp_f32 v103, v87
    v_exp_f32 v104, v88
    v_smfmac_f32_32x32x32_bf16 v[64:79], v[156:159], v[16:23], v160
    v_exp_f32 v105, v89
    v_exp_f32 v106, v90
    v_exp_f32 v107, v91
    v_exp_f32 v108, v92
    v_exp_f32 v109, v93
    v_exp_f32 v110, v94
    v_exp_f32 v111, v95
    v_mfma_f32_32x32x16_bf16 v[48:63], v[136:139], v[224:227], v[48:63]
    v_rcp_f32 v112, v112
    v_rcp_f32 v113, v113
    v_rcp_f32 v114, v114
    v_rcp_f32 v115, v115
    v_rcp_f32 v116, v116
    v_rcp_f32 v117, v117
    v_rcp_f32 v118, v118
    v_rcp_f32 v119, v119
    s_setprio 0
    s_add_u32 m0, s64, 4096
    s_nop 0
    buffer_load_dwordx4 v[168:169], s[32:35], 0 idxen offen lds
    s_add_u32 m0, s64, 5120
    s_nop 0
    buffer_load_dwordx4 v[170:171], s[32:35], 0 idxen offen lds
    s_add_u32 m0, s64, 6144
    s_nop 0
    buffer_load_dwordx4 v[172:173], s[32:35], 0 idxen offen lds
    s_add_u32 m0, s64, 7168
    s_nop 0
    buffer_load_dwordx4 v[174:175], s[32:35], 0 idxen offen lds
    s_sub_u32 s63, s63, 1
    s_cmp_le_u32 s63, s16
    s_cbranch_scc1 K2A_EXIT0
    v_mul_f32 v128, v120, v112
    v_mul_f32 v129, v121, v113
    v_mul_f32 v130, v122, v114
    v_mul_f32 v131, v123, v115
    v_mul_f32 v132, v124, v116
    v_mul_f32 v133, v125, v117
    v_mul_f32 v134, v126, v118
    v_mul_f32 v135, v127, v119
    v_add_f32 v97, 1.0, v97
    v_add_f32 v99, 1.0, v99
    v_add_f32 v101, 1.0, v101
    v_add_f32 v103, 1.0, v103
    v_add_f32 v105, 1.0, v105
    v_add_f32 v107, 1.0, v107
    v_add_f32 v109, 1.0, v109
    v_add_f32 v111, 1.0, v111
    v_fma_f32 v120, v81, v96, v81
    v_fma_f32 v121, v83, v98, v83
    v_fma_f32 v122, v85, v100, v85
    v_fma_f32 v123, v87, v102, v87
    v_fma_f32 v124, v89, v104, v89
    v_fma_f32 v125, v91, v106, v91
    v_fma_f32 v126, v93, v108, v93
    v_fma_f32 v127, v95, v110, v95
    v_fma_f32 v112, v96, v97, v97
    v_fma_f32 v113, v98, v99, v99
    v_fma_f32 v114, v100, v101, v101
    v_fma_f32 v115, v102, v103, v103
    v_fma_f32 v116, v104, v105, v105
    v_fma_f32 v117, v106, v107, v107
    v_fma_f32 v118, v108, v109, v109
    v_fma_f32 v119, v110, v111, v111
    v_fmac_f32 v120, v80, v97
    v_fmac_f32 v121, v82, v99
    v_fmac_f32 v122, v84, v101
    v_fmac_f32 v123, v86, v103
    v_fmac_f32 v124, v88, v105
    v_fmac_f32 v125, v90, v107
    v_fmac_f32 v126, v92, v109
    v_fmac_f32 v127, v94, v111
    s_setprio 2
    v_mfma_f32_32x32x16_bf16 v[80:95], v[148:151], v[8:11], 0
    v_cvt_pk_bf16_f32 v136, v128, v129
    v_cvt_pk_bf16_f32 v137, v130, v131
    v_cvt_pk_bf16_f32 v138, v132, v133
    v_cvt_pk_bf16_f32 v139, v134, v135
    v_exp_f32 v96, v64
    v_exp_f32 v97, v65
    v_exp_f32 v98, v66
    v_mfma_f32_32x32x16_bf16 v[80:95], v[152:155], v[12:15], v[80:95]
    v_exp_f32 v99, v67
    v_exp_f32 v100, v68
    v_exp_f32 v101, v69
    v_exp_f32 v102, v70
    v_exp_f32 v103, v71
    v_exp_f32 v104, v72
    v_smfmac_f32_32x32x32_bf16 v[80:95], v[156:159], v[24:31], v160
    v_exp_f32 v105, v73
    v_exp_f32 v106, v74
    v_exp_f32 v107, v75
    v_exp_f32 v108, v76
    v_exp_f32 v109, v77
    v_exp_f32 v110, v78
    v_exp_f32 v111, v79
    v_mfma_f32_32x32x16_bf16 v[32:47], v[136:139], v[164:167], v[32:47]
    v_rcp_f32 v112, v112
    v_rcp_f32 v113, v113
    v_rcp_f32 v114, v114
    v_rcp_f32 v115, v115
    v_rcp_f32 v116, v116
    v_rcp_f32 v117, v117
    v_rcp_f32 v118, v118
    v_rcp_f32 v119, v119
    s_setprio 0
    s_waitcnt vmcnt(4)
    ds_read_b128 v[140:143], v176 offset:0
    ds_read_b128 v[144:147], v177 offset:0
    ds_read_b128 v[156:159], v180 offset:4352
    ds_read_u16 v160, v5 offset:5376
    ds_read_b128 v[148:151], v178 offset:0
    ds_read_b128 v[152:155], v179 offset:0
    ds_read_b32 v168, v181 offset:512
    ds_read_b32 v170, v181 offset:544
    ds_read_b32 v172, v181 offset:576
    ds_read_b32 v174, v181 offset:608
    ds_read_b128 v[224:227], v180 offset:3328
    s_waitcnt lgkmcnt(0)
    v_mul_f32 v128, v120, v112
    v_mul_f32 v129, v121, v113
    v_mul_f32 v130, v122, v114
    v_mul_f32 v131, v123, v115
    v_mul_f32 v132, v124, v116
    v_mul_f32 v133, v125, v117
    v_mul_f32 v134, v126, v118
    v_mul_f32 v135, v127, v119
    v_add_f32 v97, 1.0, v97
    v_add_f32 v99, 1.0, v99
    v_add_f32 v101, 1.0, v101
    v_add_f32 v103, 1.0, v103
    v_add_f32 v105, 1.0, v105
    v_add_f32 v107, 1.0, v107
    v_add_f32 v109, 1.0, v109
    v_add_f32 v111, 1.0, v111
    v_fma_f32 v120, v65, v96, v65
    v_fma_f32 v121, v67, v98, v67
    v_fma_f32 v122, v69, v100, v69
    v_fma_f32 v123, v71, v102, v71
    v_fma_f32 v124, v73, v104, v73
    v_fma_f32 v125, v75, v106, v75
    v_fma_f32 v126, v77, v108, v77
    v_fma_f32 v127, v79, v110, v79
    v_fma_f32 v112, v96, v97, v97
    v_fma_f32 v113, v98, v99, v99
    v_fma_f32 v114, v100, v101, v101
    v_fma_f32 v115, v102, v103, v103
    v_fma_f32 v116, v104, v105, v105
    v_fma_f32 v117, v106, v107, v107
    v_fma_f32 v118, v108, v109, v109
    v_fma_f32 v119, v110, v111, v111
    v_fmac_f32 v120, v64, v97
    v_fmac_f32 v121, v66, v99
    v_fmac_f32 v122, v68, v101
    v_fmac_f32 v123, v70, v103
    v_fmac_f32 v124, v72, v105
    v_fmac_f32 v125, v74, v107
    v_fmac_f32 v126, v76, v109
    v_fmac_f32 v127, v78, v111
    s_setprio 2
    v_mfma_f32_32x32x16_bf16 v[64:79], v[140:143], v[8:11], 0
    v_cvt_pk_bf16_f32 v136, v128, v129
    v_cvt_pk_bf16_f32 v137, v130, v131
    v_cvt_pk_bf16_f32 v138, v132, v133
    v_cvt_pk_bf16_f32 v139, v134, v135
    v_exp_f32 v96, v80
    v_exp_f32 v97, v81
    v_exp_f32 v98, v82
    v_mfma_f32_32x32x16_bf16 v[64:79], v[144:147], v[12:15], v[64:79]
    v_exp_f32 v99, v83
    v_exp_f32 v100, v84
    v_exp_f32 v101, v85
    v_exp_f32 v102, v86
    v_exp_f32 v103, v87
    v_exp_f32 v104, v88
    v_smfmac_f32_32x32x32_bf16 v[64:79], v[156:159], v[16:23], v160
    v_exp_f32 v105, v89
    v_exp_f32 v106, v90
    v_exp_f32 v107, v91
    v_exp_f32 v108, v92
    v_exp_f32 v109, v93
    v_exp_f32 v110, v94
    v_exp_f32 v111, v95
    v_mfma_f32_32x32x16_bf16 v[48:63], v[136:139], v[164:167], v[48:63]
    v_rcp_f32 v112, v112
    v_rcp_f32 v113, v113
    v_rcp_f32 v114, v114
    v_rcp_f32 v115, v115
    v_rcp_f32 v116, v116
    v_rcp_f32 v117, v117
    v_rcp_f32 v118, v118
    v_rcp_f32 v119, v119
    s_setprio 0
    s_add_u32 m0, s64, 0
    s_nop 0
    buffer_load_dwordx4 v[168:169], s[32:35], 0 idxen offen lds
    s_add_u32 m0, s64, 1024
    s_nop 0
    buffer_load_dwordx4 v[170:171], s[32:35], 0 idxen offen lds
    s_add_u32 m0, s64, 2048
    s_nop 0
    buffer_load_dwordx4 v[172:173], s[32:35], 0 idxen offen lds
    s_add_u32 m0, s64, 3072
    s_nop 0
    buffer_load_dwordx4 v[174:175], s[32:35], 0 idxen offen lds
    s_sub_u32 s63, s63, 1
    s_cmp_le_u32 s63, s16
    s_cbranch_scc0 K2A_LOOP
K2A_EXIT1:
    v_mul_f32 v128, v120, v112
    v_mul_f32 v129, v121, v113
    v_mul_f32 v130, v122, v114
    v_mul_f32 v131, v123, v115
    v_mul_f32 v132, v124, v116
    v_mul_f32 v133, v125, v117
    v_mul_f32 v134, v126, v118
    v_mul_f32 v135, v127, v119
    v_add_f32 v97, 1.0, v97
    v_add_f32 v99, 1.0, v99
    v_add_f32 v101, 1.0, v101
    v_add_f32 v103, 1.0, v103
    v_add_f32 v105, 1.0, v105
    v_add_f32 v107, 1.0, v107
    v_add_f32 v109, 1.0, v109
    v_add_f32 v111, 1.0, v111
    v_fma_f32 v120, v81, v96, v81
    v_fma_f32 v121, v83, v98, v83
    v_fma_f32 v122, v85, v100, v85
    v_fma_f32 v123, v87, v102, v87
    v_fma_f32 v124, v89, v104, v89
    v_fma_f32 v125, v91, v106, v91
    v_fma_f32 v126, v93, v108, v93
    v_fma_f32 v127, v95, v110, v95
    v_fma_f32 v112, v96, v97, v97
    v_fma_f32 v113, v98, v99, v99
    v_fma_f32 v114, v100, v101, v101
    v_fma_f32 v115, v102, v103, v103
    v_fma_f32 v116, v104, v105, v105
    v_fma_f32 v117, v106, v107, v107
    v_fma_f32 v118, v108, v109, v109
    v_fma_f32 v119, v110, v111, v111
    v_fmac_f32 v120, v80, v97
    v_fmac_f32 v121, v82, v99
    v_fmac_f32 v122, v84, v101
    v_fmac_f32 v123, v86, v103
    v_fmac_f32 v124, v88, v105
    v_fmac_f32 v125, v90, v107
    v_fmac_f32 v126, v92, v109
    v_fmac_f32 v127, v94, v111
    s_cmp_lg_u32 s63, 0
    s_cbranch_scc1 K2B_LOOP
    v_cvt_pk_bf16_f32 v136, v128, v129
    v_cvt_pk_bf16_f32 v137, v130, v131
    v_cvt_pk_bf16_f32 v138, v132, v133
    v_cvt_pk_bf16_f32 v139, v134, v135
    v_rcp_f32 v112, v112
    v_rcp_f32 v113, v113
    v_mfma_f32_32x32x16_bf16 v[32:47], v[136:139], v[224:227], v[32:47]
    v_rcp_f32 v114, v114
    v_rcp_f32 v115, v115
    v_rcp_f32 v116, v116
    v_rcp_f32 v117, v117
    v_rcp_f32 v118, v118
    v_rcp_f32 v119, v119
    s_nop 0
    v_mul_f32 v128, v120, v112
    v_mul_f32 v129, v121, v113
    v_mul_f32 v130, v122, v114
    v_mul_f32 v131, v123, v115
    v_mul_f32 v132, v124, v116
    v_mul_f32 v133, v125, v117
    v_mul_f32 v134, v126, v118
    v_mul_f32 v135, v127, v119
    v_cvt_pk_bf16_f32 v136, v128, v129
    v_cvt_pk_bf16_f32 v137, v130, v131
    v_cvt_pk_bf16_f32 v138, v132, v133
    v_cvt_pk_bf16_f32 v139, v134, v135
    s_nop 1
    v_mfma_f32_32x32x16_bf16 v[48:63], v[136:139], v[224:227], v[48:63]
    s_branch K2_EPI
K2A_EXIT0:
    v_mul_f32 v128, v120, v112
    v_mul_f32 v129, v121, v113
    v_mul_f32 v130, v122, v114
    v_mul_f32 v131, v123, v115
    v_mul_f32 v132, v124, v116
    v_mul_f32 v133, v125, v117
    v_mul_f32 v134, v126, v118
    v_mul_f32 v135, v127, v119
    v_add_f32 v97, 1.0, v97
    v_add_f32 v99, 1.0, v99
    v_add_f32 v101, 1.0, v101
    v_add_f32 v103, 1.0, v103
    v_add_f32 v105, 1.0, v105
    v_add_f32 v107, 1.0, v107
    v_add_f32 v109, 1.0, v109
    v_add_f32 v111, 1.0, v111
    v_fma_f32 v120, v81, v96, v81
    v_fma_f32 v121, v83, v98, v83
    v_fma_f32 v122, v85, v100, v85
    v_fma_f32 v123, v87, v102, v87
    v_fma_f32 v124, v89, v104, v89
    v_fma_f32 v125, v91, v106, v91
    v_fma_f32 v126, v93, v108, v93
    v_fma_f32 v127, v95, v110, v95
    v_fma_f32 v112, v96, v97, v97
    v_fma_f32 v113, v98, v99, v99
    v_fma_f32 v114, v100, v101, v101
    v_fma_f32 v115, v102, v103, v103
    v_fma_f32 v116, v104, v105, v105
    v_fma_f32 v117, v106, v107, v107
    v_fma_f32 v118, v108, v109, v109
    v_fma_f32 v119, v110, v111, v111
    v_fmac_f32 v120, v80, v97
    v_fmac_f32 v121, v82, v99
    v_fmac_f32 v122, v84, v101
    v_fmac_f32 v123, v86, v103
    v_fmac_f32 v124, v88, v105
    v_fmac_f32 v125, v90, v107
    v_fmac_f32 v126, v92, v109
    v_fmac_f32 v127, v94, v111
    s_cmp_lg_u32 s63, 0
    s_cbranch_scc1 K2B_MID
    v_cvt_pk_bf16_f32 v136, v128, v129
    v_cvt_pk_bf16_f32 v137, v130, v131
    v_cvt_pk_bf16_f32 v138, v132, v133
    v_cvt_pk_bf16_f32 v139, v134, v135
    v_rcp_f32 v112, v112
    v_rcp_f32 v113, v113
    v_mfma_f32_32x32x16_bf16 v[32:47], v[136:139], v[164:167], v[32:47]
    v_rcp_f32 v114, v114
    v_rcp_f32 v115, v115
    v_rcp_f32 v116, v116
    v_rcp_f32 v117, v117
    v_rcp_f32 v118, v118
    v_rcp_f32 v119, v119
    s_nop 0
    v_mul_f32 v128, v120, v112
    v_mul_f32 v129, v121, v113
    v_mul_f32 v130, v122, v114
    v_mul_f32 v131, v123, v115
    v_mul_f32 v132, v124, v116
    v_mul_f32 v133, v125, v117
    v_mul_f32 v134, v126, v118
    v_mul_f32 v135, v127, v119
    v_cvt_pk_bf16_f32 v136, v128, v129
    v_cvt_pk_bf16_f32 v137, v130, v131
    v_cvt_pk_bf16_f32 v138, v132, v133
    v_cvt_pk_bf16_f32 v139, v134, v135
    s_nop 1
    v_mfma_f32_32x32x16_bf16 v[48:63], v[136:139], v[164:167], v[48:63]
    s_branch K2_EPI
K2_FB:
    s_nop 1
    s_setprio 1
    v_mfma_f32_32x32x16_bf16 v[80:95], v[148:151], v[8:11], 0
    v_exp_f32 v96, v64
    v_exp_f32 v97, v65
    v_exp_f32 v98, v66
    v_exp_f32 v99, v67
    v_exp_f32 v100, v68
    v_mfma_f32_32x32x16_bf16 v[80:95], v[152:155], v[12:15], v[80:95]
    v_exp_f32 v101, v69
    v_exp_f32 v102, v70
    v_exp_f32 v103, v71
    v_exp_f32 v104, v72
    v_exp_f32 v105, v73
    v_smfmac_f32_32x32x32_bf16 v[80:95], v[156:159], v[24:31], v160
    v_exp_f32 v106, v74
    v_exp_f32 v107, v75
    v_exp_f32 v108, v76
    v_exp_f32 v109, v77
    v_exp_f32 v110, v78
    v_exp_f32 v111, v79
    s_setprio 0
    v_add_f32 v97, 1.0, v97
    v_add_f32 v99, 1.0, v99
    v_add_f32 v101, 1.0, v101
    v_add_f32 v103, 1.0, v103
    v_add_f32 v105, 1.0, v105
    v_add_f32 v107, 1.0, v107
    v_add_f32 v109, 1.0, v109
    v_add_f32 v111, 1.0, v111
    v_fma_f32 v120, v65, v96, v65
    v_fma_f32 v121, v67, v98, v67
    v_fma_f32 v122, v69, v100, v69
    v_fma_f32 v123, v71, v102, v71
    v_fma_f32 v124, v73, v104, v73
    v_fma_f32 v125, v75, v106, v75
    v_fma_f32 v126, v77, v108, v77
    v_fma_f32 v127, v79, v110, v79
    v_fma_f32 v112, v96, v97, v97
    v_fma_f32 v113, v98, v99, v99
    v_fma_f32 v114, v100, v101, v101
    v_fma_f32 v115, v102, v103, v103
    v_fma_f32 v116, v104, v105, v105
    v_fma_f32 v117, v106, v107, v107
    v_fma_f32 v118, v108, v109, v109
    v_fma_f32 v119, v110, v111, v111
    v_fmac_f32 v120, v64, v97
    v_fmac_f32 v121, v66, v99
    v_fmac_f32 v122, v68, v101
    v_fmac_f32 v123, v70, v103
    v_fmac_f32 v124, v72, v105
    v_fmac_f32 v125, v74, v107
    v_fmac_f32 v126, v76, v109
    v_fmac_f32 v127, v78, v111
    s_waitcnt vmcnt(4)
    ds_read_b128 v[140:143], v176 offset:4096
    ds_read_b128 v[144:147], v177 offset:4096
    ds_read_b128 v[156:159], v180 offset:2176
    ds_read_u16 v160, v5 offset:3200
    ds_read_b128 v[148:151], v178 offset:4096
    ds_read_b128 v[152:155], v179 offset:4096
    ds_read_b32 v168, v181 offset:384
    ds_read_b32 v170, v181 offset:416
    ds_read_b32 v172, v181 offset:448
    ds_read_b32 v174, v181 offset:480
    ds_read_b128 v[164:167], v180 offset:1152
    s_setprio 1
    v_exp_f32 v96, v80
    v_exp_f32 v97, v81
    v_exp_f32 v98, v82
    v_exp_f32 v99, v83
    v_exp_f32 v100, v84
    v_exp_f32 v101, v85
    v_exp_f32 v102, v86
    v_exp_f32 v103, v87
    v_exp_f32 v104, v88
    v_exp_f32 v105, v89
    s_waitcnt lgkmcnt(0)
    v_mfma_f32_32x32x16_bf16 v[64:79], v[140:143], v[8:11], 0
    v_exp_f32 v106, v90
    v_exp_f32 v107, v91
    v_exp_f32 v108, v92
    v_exp_f32 v109, v93
    v_exp_f32 v110, v94
    v_mfma_f32_32x32x16_bf16 v[64:79], v[144:147], v[12:15], v[64:79]
    v_exp_f32 v111, v95
    v_rcp_f32 v112, v112
    v_rcp_f32 v113, v113
    v_rcp_f32 v114, v114
    v_rcp_f32 v115, v115
    v_smfmac_f32_32x32x32_bf16 v[64:79], v[156:159], v[16:23], v160
    v_rcp_f32 v116, v116
    v_rcp_f32 v117, v117
    v_rcp_f32 v118, v118
    v_rcp_f32 v119, v119
    s_setprio 0
    v_mul_f32 v128, v120, v112
    v_mul_f32 v129, v121, v113
    v_mul_f32 v130, v122, v114
    v_mul_f32 v131, v123, v115
    v_mul_f32 v132, v124, v116
    v_mul_f32 v133, v125, v117
    v_mul_f32 v134, v126, v118
    v_mul_f32 v135, v127, v119
    v_add_f32 v97, 1.0, v97
    v_add_f32 v99, 1.0, v99
    v_add_f32 v101, 1.0, v101
    v_add_f32 v103, 1.0, v103
    v_add_f32 v105, 1.0, v105
    v_add_f32 v107, 1.0, v107
    v_add_f32 v109, 1.0, v109
    v_add_f32 v111, 1.0, v111
    v_fma_f32 v120, v81, v96, v81
    v_fma_f32 v121, v83, v98, v83
    v_fma_f32 v122, v85, v100, v85
    v_fma_f32 v123, v87, v102, v87
    v_fma_f32 v124, v89, v104, v89
    v_fma_f32 v125, v91, v106, v91
    v_fma_f32 v126, v93, v108, v93
    v_fma_f32 v127, v95, v110, v95
    v_fma_f32 v112, v96, v97, v97
    v_fma_f32 v113, v98, v99, v99
    v_fma_f32 v114, v100, v101, v101
    v_fma_f32 v115, v102, v103, v103
    v_fma_f32 v116, v104, v105, v105
    v_fma_f32 v117, v106, v107, v107
    v_fma_f32 v118, v108, v109, v109
    v_fma_f32 v119, v110, v111, v111
    v_fmac_f32 v120, v80, v97
    v_fmac_f32 v121, v82, v99
    v_fmac_f32 v122, v84, v101
    v_fmac_f32 v123, v86, v103
    v_fmac_f32 v124, v88, v105
    v_fmac_f32 v125, v90, v107
    v_fmac_f32 v126, v92, v109
    v_fmac_f32 v127, v94, v111
    s_add_u32 m0, s64, 4096
    s_nop 0
    buffer_load_dwordx4 v[168:169], s[32:35], 0 idxen offen lds
    s_add_u32 m0, s64, 5120
    s_nop 0
    buffer_load_dwordx4 v[170:171], s[32:35], 0 idxen offen lds
    s_add_u32 m0, s64, 6144
    s_nop 0
    buffer_load_dwordx4 v[172:173], s[32:35], 0 idxen offen lds
    s_add_u32 m0, s64, 7168
    s_nop 0
    buffer_load_dwordx4 v[174:175], s[32:35], 0 idxen offen lds
    s_sub_u32 s63, s63, 1
    s_cmp_le_u32 s63, 0
    s_setprio 1
    v_mfma_f32_32x32x16_bf16 v[80:95], v[148:151], v[8:11], 0
    v_cvt_pk_bf16_f32 v136, v128, v129
    v_cvt_pk_bf16_f32 v137, v130, v131
    v_cvt_pk_bf16_f32 v138, v132, v133
    v_cvt_pk_bf16_f32 v139, v134, v135
    v_exp_f32 v96, v64
    v_exp_f32 v97, v65
    v_exp_f32 v98, v66
    v_mfma_f32_32x32x16_bf16 v[80:95], v[152:155], v[12:15], v[80:95]
    v_exp_f32 v99, v67
    v_exp_f32 v100, v68
    v_exp_f32 v101, v69
    v_exp_f32 v102, v70
    v_exp_f32 v103, v71
    v_exp_f32 v104, v72
    v_smfmac_f32_32x32x32_bf16 v[80:95], v[156:159], v[24:31], v160
    v_exp_f32 v105, v73
    v_exp_f32 v106, v74
    v_exp_f32 v107, v75
    v_exp_f32 v108, v76
    v_exp_f32 v109, v77
    v_exp_f32 v110, v78
    v_exp_f32 v111, v79
    v_mfma_f32_32x32x16_bf16 v[32:47], v[136:139], v[164:167], 0
    v_rcp_f32 v112, v112
    v_rcp_f32 v113, v113
    v_rcp_f32 v114, v114
    v_rcp_f32 v115, v115
    v_rcp_f32 v116, v116
    v_rcp_f32 v117, v117
    v_rcp_f32 v118, v118
    v_rcp_f32 v119, v119
    s_setprio 0
    v_mul_f32 v128, v120, v112
    v_mul_f32 v129, v121, v113
    v_mul_f32 v130, v122, v114
    v_mul_f32 v131, v123, v115
    v_mul_f32 v132, v124, v116
    v_mul_f32 v133, v125, v117
    v_mul_f32 v134, v126, v118
    v_mul_f32 v135, v127, v119
    v_add_f32 v97, 1.0, v97
    v_add_f32 v99, 1.0, v99
    v_add_f32 v101, 1.0, v101
    v_add_f32 v103, 1.0, v103
    v_add_f32 v105, 1.0, v105
    v_add_f32 v107, 1.0, v107
    v_add_f32 v109, 1.0, v109
    v_add_f32 v111, 1.0, v111
    v_fma_f32 v120, v65, v96, v65
    v_fma_f32 v121, v67, v98, v67
    v_fma_f32 v122, v69, v100, v69
    v_fma_f32 v123, v71, v102, v71
    v_fma_f32 v124, v73, v104, v73
    v_fma_f32 v125, v75, v106, v75
    v_fma_f32 v126, v77, v108, v77
    v_fma_f32 v127, v79, v110, v79
    v_fma_f32 v112, v96, v97, v97
    v_fma_f32 v113, v98, v99, v99
    v_fma_f32 v114, v100, v101, v101
    v_fma_f32 v115, v102, v103, v103
    v_fma_f32 v116, v104, v105, v105
    v_fma_f32 v117, v106, v107, v107
    v_fma_f32 v118, v108, v109, v109
    v_fma_f32 v119, v110, v111, v111
    v_fmac_f32 v120, v64, v97
    v_fmac_f32 v121, v66, v99
    v_fmac_f32 v122, v68, v101
    v_fmac_f32 v123, v70, v103
    v_fmac_f32 v124, v72, v105
    v_fmac_f32 v125, v74, v107
    v_fmac_f32 v126, v76, v109
    v_fmac_f32 v127, v78, v111
    s_waitcnt vmcnt(4)
    ds_read_b128 v[140:143], v176 offset:0
    ds_read_b128 v[144:147], v177 offset:0
    ds_read_b128 v[156:159], v180 offset:4352
    ds_read_u16 v160, v5 offset:5376
    ds_read_b128 v[148:151], v178 offset:0
    ds_read_b128 v[152:155], v179 offset:0
    ds_read_b32 v168, v181 offset:512
    ds_read_b32 v170, v181 offset:544
    ds_read_b32 v172, v181 offset:576
    ds_read_b32 v174, v181 offset:608
    ds_read_b128 v[224:227], v180 offset:3328
    s_setprio 1
    v_cvt_pk_bf16_f32 v136, v128, v129
    v_cvt_pk_bf16_f32 v137, v130, v131
    v_cvt_pk_bf16_f32 v138, v132, v133
    v_cvt_pk_bf16_f32 v139, v134, v135
    v_exp_f32 v96, v80
    v_exp_f32 v97, v81
    v_mfma_f32_32x32x16_bf16 v[48:63], v[136:139], v[164:167], 0
    v_exp_f32 v98, v82
    v_exp_f32 v99, v83
    v_exp_f32 v100, v84
    v_exp_f32 v101, v85
    v_exp_f32 v102, v86
    v_exp_f32 v103, v87
    s_waitcnt lgkmcnt(0)
    v_mfma_f32_32x32x16_bf16 v[64:79], v[140:143], v[8:11], 0
    v_exp_f32 v104, v88
    v_exp_f32 v105, v89
    v_exp_f32 v106, v90
    v_exp_f32 v107, v91
    v_exp_f32 v108, v92
    v_mfma_f32_32x32x16_bf16 v[64:79], v[144:147], v[12:15], v[64:79]
    v_exp_f32 v109, v93
    v_exp_f32 v110, v94
    v_exp_f32 v111, v95
    v_rcp_f32 v112, v112
    v_rcp_f32 v113, v113
    v_smfmac_f32_32x32x32_bf16 v[64:79], v[156:159], v[16:23], v160
    v_rcp_f32 v114, v114
    v_rcp_f32 v115, v115
    v_rcp_f32 v116, v116
    v_rcp_f32 v117, v117
    v_rcp_f32 v118, v118
    v_rcp_f32 v119, v119
    s_setprio 0
    v_mul_f32 v128, v120, v112
    v_mul_f32 v129, v121, v113
    v_mul_f32 v130, v122, v114
    v_mul_f32 v131, v123, v115
    v_mul_f32 v132, v124, v116
    v_mul_f32 v133, v125, v117
    v_mul_f32 v134, v126, v118
    v_mul_f32 v135, v127, v119
    v_add_f32 v97, 1.0, v97
    v_add_f32 v99, 1.0, v99
    v_add_f32 v101, 1.0, v101
    v_add_f32 v103, 1.0, v103
    v_add_f32 v105, 1.0, v105
    v_add_f32 v107, 1.0, v107
    v_add_f32 v109, 1.0, v109
    v_add_f32 v111, 1.0, v111
    v_fma_f32 v120, v81, v96, v81
    v_fma_f32 v121, v83, v98, v83
    v_fma_f32 v122, v85, v100, v85
    v_fma_f32 v123, v87, v102, v87
    v_fma_f32 v124, v89, v104, v89
    v_fma_f32 v125, v91, v106, v91
    v_fma_f32 v126, v93, v108, v93
    v_fma_f32 v127, v95, v110, v95
    v_fma_f32 v112, v96, v97, v97
    v_fma_f32 v113, v98, v99, v99
    v_fma_f32 v114, v100, v101, v101
    v_fma_f32 v115, v102, v103, v103
    v_fma_f32 v116, v104, v105, v105
    v_fma_f32 v117, v106, v107, v107
    v_fma_f32 v118, v108, v109, v109
    v_fma_f32 v119, v110, v111, v111
    v_fmac_f32 v120, v80, v97
    v_fmac_f32 v121, v82, v99
    v_fmac_f32 v122, v84, v101
    v_fmac_f32 v123, v86, v103
    v_fmac_f32 v124, v88, v105
    v_fmac_f32 v125, v90, v107
    v_fmac_f32 v126, v92, v109
    v_fmac_f32 v127, v94, v111
    s_add_u32 m0, s64, 0
    s_nop 0
    buffer_load_dwordx4 v[168:169], s[32:35], 0 idxen offen lds
    s_add_u32 m0, s64, 1024
    s_nop 0
    buffer_load_dwordx4 v[170:171], s[32:35], 0 idxen offen lds
    s_add_u32 m0, s64, 2048
    s_nop 0
    buffer_load_dwordx4 v[172:173], s[32:35], 0 idxen offen lds
    s_add_u32 m0, s64, 3072
    s_nop 0
    buffer_load_dwordx4 v[174:175], s[32:35], 0 idxen offen lds
    s_sub_u32 s63, s63, 1
    s_cmp_le_u32 s63, 0
    s_cbranch_scc1 K2B_EXIT1
.p2align 6
K2B_LOOP:
    s_setprio 1
    v_mfma_f32_32x32x16_bf16 v[80:95], v[148:151], v[8:11], 0
    v_cvt_pk_bf16_f32 v136, v128, v129
    v_cvt_pk_bf16_f32 v137, v130, v131
    v_cvt_pk_bf16_f32 v138, v132, v133
    v_cvt_pk_bf16_f32 v139, v134, v135
    v_exp_f32 v96, v64
    v_exp_f32 v97, v65
    v_exp_f32 v98, v66
    v_mfma_f32_32x32x16_bf16 v[80:95], v[152:155], v[12:15], v[80:95]
    v_exp_f32 v99, v67
    v_exp_f32 v100, v68
    v_exp_f32 v101, v69
    v_exp_f32 v102, v70
    v_exp_f32 v103, v71
    v_exp_f32 v104, v72
    v_smfmac_f32_32x32x32_bf16 v[80:95], v[156:159], v[24:31], v160
    v_exp_f32 v105, v73
    v_exp_f32 v106, v74
    v_exp_f32 v107, v75
    v_exp_f32 v108, v76
    v_exp_f32 v109, v77
    v_exp_f32 v110, v78
    v_exp_f32 v111, v79
    v_mfma_f32_32x32x16_bf16 v[32:47], v[136:139], v[224:227], v[32:47]
    v_rcp_f32 v112, v112
    v_rcp_f32 v113, v113
    v_rcp_f32 v114, v114
    v_rcp_f32 v115, v115
    v_rcp_f32 v116, v116
    v_rcp_f32 v117, v117
    v_rcp_f32 v118, v118
    v_rcp_f32 v119, v119
    s_setprio 0
    v_add_u32 v180, 4352, v180
    v_add_u32 v5, 4352, v5
    v_add_u32 v181, 256, v181
    v_mul_f32 v128, v120, v112
    v_mul_f32 v129, v121, v113
    v_mul_f32 v130, v122, v114
    v_mul_f32 v131, v123, v115
    v_mul_f32 v132, v124, v116
    v_mul_f32 v133, v125, v117
    v_mul_f32 v134, v126, v118
    v_mul_f32 v135, v127, v119
    v_add_f32 v97, 1.0, v97
    v_add_f32 v99, 1.0, v99
    v_add_f32 v101, 1.0, v101
    v_add_f32 v103, 1.0, v103
    v_add_f32 v105, 1.0, v105
    v_add_f32 v107, 1.0, v107
    v_add_f32 v109, 1.0, v109
    v_add_f32 v111, 1.0, v111
    v_fma_f32 v120, v65, v96, v65
    v_fma_f32 v121, v67, v98, v67
    v_fma_f32 v122, v69, v100, v69
    v_fma_f32 v123, v71, v102, v71
    v_fma_f32 v124, v73, v104, v73
    v_fma_f32 v125, v75, v106, v75
    v_fma_f32 v126, v77, v108, v77
    v_fma_f32 v127, v79, v110, v79
    v_fma_f32 v112, v96, v97, v97
    v_fma_f32 v113, v98, v99, v99
    v_fma_f32 v114, v100, v101, v101
    v_fma_f32 v115, v102, v103, v103
    v_fma_f32 v116, v104, v105, v105
    v_fma_f32 v117, v106, v107, v107
    v_fma_f32 v118, v108, v109, v109
    v_fma_f32 v119, v110, v111, v111
    v_fmac_f32 v120, v64, v97
    v_fmac_f32 v121, v66, v99
    v_fmac_f32 v122, v68, v101
    v_fmac_f32 v123, v70, v103
    v_fmac_f32 v124, v72, v105
    v_fmac_f32 v125, v74, v107
    v_fmac_f32 v126, v76, v109
    v_fmac_f32 v127, v78, v111
    s_waitcnt vmcnt(4)
    ds_read_b128 v[140:143], v176 offset:4096
    ds_read_b128 v[144:147], v177 offset:4096
    ds_read_b128 v[156:159], v180 offset:2176
    ds_read_u16 v160, v5 offset:3200
    ds_read_b128 v[148:151], v178 offset:4096
    ds_read_b128 v[152:155], v179 offset:4096
    ds_read_b32 v168, v181 offset:384
    ds_read_b32 v170, v181 offset:416
    ds_read_b32 v172, v181 offset:448
    ds_read_b32 v174, v181 offset:480
    ds_read_b128 v[164:167], v180 offset:1152
    s_setprio 1
    v_cvt_pk_bf16_f32 v136, v128, v129
    v_cvt_pk_bf16_f32 v137, v130, v131
    v_cvt_pk_bf16_f32 v138, v132, v133
    v_cvt_pk_bf16_f32 v139, v134, v135
    v_exp_f32 v96, v80
    v_exp_f32 v97, v81
    v_mfma_f32_32x32x16_bf16 v[48:63], v[136:139], v[224:227], v[48:63]
    v_exp_f32 v98, v82
    v_exp_f32 v99, v83
    v_exp_f32 v100, v84
    v_exp_f32 v101, v85
    v_exp_f32 v102, v86
    v_exp_f32 v103, v87
    s_waitcnt lgkmcnt(0)
    v_mfma_f32_32x32x16_bf16 v[64:79], v[140:143], v[8:11], 0
    v_exp_f32 v104, v88
    v_exp_f32 v105, v89
    v_exp_f32 v106, v90
    v_exp_f32 v107, v91
    v_exp_f32 v108, v92
    v_mfma_f32_32x32x16_bf16 v[64:79], v[144:147], v[12:15], v[64:79]
    v_exp_f32 v109, v93
    v_exp_f32 v110, v94
    v_exp_f32 v111, v95
    v_rcp_f32 v112, v112
    v_rcp_f32 v113, v113
    v_smfmac_f32_32x32x32_bf16 v[64:79], v[156:159], v[16:23], v160
    v_rcp_f32 v114, v114
    v_rcp_f32 v115, v115
    v_rcp_f32 v116, v116
    v_rcp_f32 v117, v117
    v_rcp_f32 v118, v118
    v_rcp_f32 v119, v119
    s_setprio 0
    v_mul_f32 v128, v120, v112
    v_mul_f32 v129, v121, v113
    v_mul_f32 v130, v122, v114
    v_mul_f32 v131, v123, v115
    v_mul_f32 v132, v124, v116
    v_mul_f32 v133, v125, v117
    v_mul_f32 v134, v126, v118
    v_mul_f32 v135, v127, v119
    v_add_f32 v97, 1.0, v97
    v_add_f32 v99, 1.0, v99
    v_add_f32 v101, 1.0, v101
    v_add_f32 v103, 1.0, v103
    v_add_f32 v105, 1.0, v105
    v_add_f32 v107, 1.0, v107
    v_add_f32 v109, 1.0, v109
    v_add_f32 v111, 1.0, v111
    v_fma_f32 v120, v81, v96, v81
    v_fma_f32 v121, v83, v98, v83
    v_fma_f32 v122, v85, v100, v85
    v_fma_f32 v123, v87, v102, v87
    v_fma_f32 v124, v89, v104, v89
    v_fma_f32 v125, v91, v106, v91
    v_fma_f32 v126, v93, v108, v93
    v_fma_f32 v127, v95, v110, v95
    v_fma_f32 v112, v96, v97, v97
    v_fma_f32 v113, v98, v99, v99
    v_fma_f32 v114, v100, v101, v101
    v_fma_f32 v115, v102, v103, v103
    v_fma_f32 v116, v104, v105, v105
    v_fma_f32 v117, v106, v107, v107
    v_fma_f32 v118, v108, v109, v109
    v_fma_f32 v119, v110, v111, v111
    v_fmac_f32 v120, v80, v97
    v_fmac_f32 v121, v82, v99
    v_fmac_f32 v122, v84, v101
    v_fmac_f32 v123, v86, v103
    v_fmac_f32 v124, v88, v105
    v_fmac_f32 v125, v90, v107
    v_fmac_f32 v126, v92, v109
    v_fmac_f32 v127, v94, v111
    s_add_u32 m0, s64, 4096
    s_nop 0
    buffer_load_dwordx4 v[168:169], s[32:35], 0 idxen offen lds
    s_add_u32 m0, s64, 5120
    s_nop 0
    buffer_load_dwordx4 v[170:171], s[32:35], 0 idxen offen lds
    s_add_u32 m0, s64, 6144
    s_nop 0
    buffer_load_dwordx4 v[172:173], s[32:35], 0 idxen offen lds
    s_add_u32 m0, s64, 7168
    s_nop 0
    buffer_load_dwordx4 v[174:175], s[32:35], 0 idxen offen lds
    s_sub_u32 s63, s63, 1
    s_cmp_le_u32 s63, 0
    s_cbranch_scc1 K2B_EXIT0
K2B_MID:
    s_setprio 1
    v_mfma_f32_32x32x16_bf16 v[80:95], v[148:151], v[8:11], 0
    v_cvt_pk_bf16_f32 v136, v128, v129
    v_cvt_pk_bf16_f32 v137, v130, v131
    v_cvt_pk_bf16_f32 v138, v132, v133
    v_cvt_pk_bf16_f32 v139, v134, v135
    v_exp_f32 v96, v64
    v_exp_f32 v97, v65
    v_exp_f32 v98, v66
    v_mfma_f32_32x32x16_bf16 v[80:95], v[152:155], v[12:15], v[80:95]
    v_exp_f32 v99, v67
    v_exp_f32 v100, v68
    v_exp_f32 v101, v69
    v_exp_f32 v102, v70
    v_exp_f32 v103, v71
    v_exp_f32 v104, v72
    v_smfmac_f32_32x32x32_bf16 v[80:95], v[156:159], v[24:31], v160
    v_exp_f32 v105, v73
    v_exp_f32 v106, v74
    v_exp_f32 v107, v75
    v_exp_f32 v108, v76
    v_exp_f32 v109, v77
    v_exp_f32 v110, v78
    v_exp_f32 v111, v79
    v_mfma_f32_32x32x16_bf16 v[32:47], v[136:139], v[164:167], v[32:47]
    v_rcp_f32 v112, v112
    v_rcp_f32 v113, v113
    v_rcp_f32 v114, v114
    v_rcp_f32 v115, v115
    v_rcp_f32 v116, v116
    v_rcp_f32 v117, v117
    v_rcp_f32 v118, v118
    v_rcp_f32 v119, v119
    s_setprio 0
    v_mul_f32 v128, v120, v112
    v_mul_f32 v129, v121, v113
    v_mul_f32 v130, v122, v114
    v_mul_f32 v131, v123, v115
    v_mul_f32 v132, v124, v116
    v_mul_f32 v133, v125, v117
    v_mul_f32 v134, v126, v118
    v_mul_f32 v135, v127, v119
    v_add_f32 v97, 1.0, v97
    v_add_f32 v99, 1.0, v99
    v_add_f32 v101, 1.0, v101
    v_add_f32 v103, 1.0, v103
    v_add_f32 v105, 1.0, v105
    v_add_f32 v107, 1.0, v107
    v_add_f32 v109, 1.0, v109
    v_add_f32 v111, 1.0, v111
    v_fma_f32 v120, v65, v96, v65
    v_fma_f32 v121, v67, v98, v67
    v_fma_f32 v122, v69, v100, v69
    v_fma_f32 v123, v71, v102, v71
    v_fma_f32 v124, v73, v104, v73
    v_fma_f32 v125, v75, v106, v75
    v_fma_f32 v126, v77, v108, v77
    v_fma_f32 v127, v79, v110, v79
    v_fma_f32 v112, v96, v97, v97
    v_fma_f32 v113, v98, v99, v99
    v_fma_f32 v114, v100, v101, v101
    v_fma_f32 v115, v102, v103, v103
    v_fma_f32 v116, v104, v105, v105
    v_fma_f32 v117, v106, v107, v107
    v_fma_f32 v118, v108, v109, v109
    v_fma_f32 v119, v110, v111, v111
    v_fmac_f32 v120, v64, v97
    v_fmac_f32 v121, v66, v99
    v_fmac_f32 v122, v68, v101
    v_fmac_f32 v123, v70, v103
    v_fmac_f32 v124, v72, v105
    v_fmac_f32 v125, v74, v107
    v_fmac_f32 v126, v76, v109
    v_fmac_f32 v127, v78, v111
    s_waitcnt vmcnt(4)
    ds_read_b128 v[140:143], v176 offset:0
    ds_read_b128 v[144:147], v177 offset:0
    ds_read_b128 v[156:159], v180 offset:4352
    ds_read_u16 v160, v5 offset:5376
    ds_read_b128 v[148:151], v178 offset:0
    ds_read_b128 v[152:155], v179 offset:0
    ds_read_b32 v168, v181 offset:512
    ds_read_b32 v170, v181 offset:544
    ds_read_b32 v172, v181 offset:576
    ds_read_b32 v174, v181 offset:608
    ds_read_b128 v[224:227], v180 offset:3328
    s_setprio 1
    v_cvt_pk_bf16_f32 v136, v128, v129
    v_cvt_pk_bf16_f32 v137, v130, v131
    v_cvt_pk_bf16_f32 v138, v132, v133
    v_cvt_pk_bf16_f32 v139, v134, v135
    v_exp_f32 v96, v80
    v_exp_f32 v97, v81
    v_mfma_f32_32x32x16_bf16 v[48:63], v[136:139], v[164:167], v[48:63]
    v_exp_f32 v98, v82
    v_exp_f32 v99, v83
    v_exp_f32 v100, v84
    v_exp_f32 v101, v85
    v_exp_f32 v102, v86
    v_exp_f32 v103, v87
    s_waitcnt lgkmcnt(0)
    v_mfma_f32_32x32x16_bf16 v[64:79], v[140:143], v[8:11], 0
    v_exp_f32 v104, v88
    v_exp_f32 v105, v89
    v_exp_f32 v106, v90
    v_exp_f32 v107, v91
    v_exp_f32 v108, v92
    v_mfma_f32_32x32x16_bf16 v[64:79], v[144:147], v[12:15], v[64:79]
    v_exp_f32 v109, v93
    v_exp_f32 v110, v94
    v_exp_f32 v111, v95
    v_rcp_f32 v112, v112
    v_rcp_f32 v113, v113
    v_smfmac_f32_32x32x32_bf16 v[64:79], v[156:159], v[16:23], v160
    v_rcp_f32 v114, v114
    v_rcp_f32 v115, v115
    v_rcp_f32 v116, v116
    v_rcp_f32 v117, v117
    v_rcp_f32 v118, v118
    v_rcp_f32 v119, v119
    s_setprio 0
    v_mul_f32 v128, v120, v112
    v_mul_f32 v129, v121, v113
    v_mul_f32 v130, v122, v114
    v_mul_f32 v131, v123, v115
    v_mul_f32 v132, v124, v116
    v_mul_f32 v133, v125, v117
    v_mul_f32 v134, v126, v118
    v_mul_f32 v135, v127, v119
    v_add_f32 v97, 1.0, v97
    v_add_f32 v99, 1.0, v99
    v_add_f32 v101, 1.0, v101
    v_add_f32 v103, 1.0, v103
    v_add_f32 v105, 1.0, v105
    v_add_f32 v107, 1.0, v107
    v_add_f32 v109, 1.0, v109
    v_add_f32 v111, 1.0, v111
    v_fma_f32 v120, v81, v96, v81
    v_fma_f32 v121, v83, v98, v83
    v_fma_f32 v122, v85, v100, v85
    v_fma_f32 v123, v87, v102, v87
    v_fma_f32 v124, v89, v104, v89
    v_fma_f32 v125, v91, v106, v91
    v_fma_f32 v126, v93, v108, v93
    v_fma_f32 v127, v95, v110, v95
    v_fma_f32 v112, v96, v97, v97
    v_fma_f32 v113, v98, v99, v99
    v_fma_f32 v114, v100, v101, v101
    v_fma_f32 v115, v102, v103, v103
    v_fma_f32 v116, v104, v105, v105
    v_fma_f32 v117, v106, v107, v107
    v_fma_f32 v118, v108, v109, v109
    v_fma_f32 v119, v110, v111, v111
    v_fmac_f32 v120, v80, v97
    v_fmac_f32 v121, v82, v99
    v_fmac_f32 v122, v84, v101
    v_fmac_f32 v123, v86, v103
    v_fmac_f32 v124, v88, v105
    v_fmac_f32 v125, v90, v107
    v_fmac_f32 v126, v92, v109
    v_fmac_f32 v127, v94, v111
    s_add_u32 m0, s64, 0
    s_nop 0
    buffer_load_dwordx4 v[168:169], s[32:35], 0 idxen offen lds
    s_add_u32 m0, s64, 1024
    s_nop 0
    buffer_load_dwordx4 v[170:171], s[32:35], 0 idxen offen lds
    s_add_u32 m0, s64, 2048
    s_nop 0
    buffer_load_dwordx4 v[172:173], s[32:35], 0 idxen offen lds
    s_add_u32 m0, s64, 3072
    s_nop 0
    buffer_load_dwordx4 v[174:175], s[32:35], 0 idxen offen lds
    s_sub_u32 s63, s63, 1
    s_cmp_le_u32 s63, 0
    s_cbranch_scc0 K2B_LOOP
K2B_EXIT1:
    v_cvt_pk_bf16_f32 v136, v128, v129
    v_cvt_pk_bf16_f32 v137, v130, v131
    v_cvt_pk_bf16_f32 v138, v132, v133
    v_cvt_pk_bf16_f32 v139, v134, v135
    v_rcp_f32 v112, v112
    v_rcp_f32 v113, v113
    v_mfma_f32_32x32x16_bf16 v[32:47], v[136:139], v[224:227], v[32:47]
    v_rcp_f32 v114, v114
    v_rcp_f32 v115, v115
    v_rcp_f32 v116, v116
    v_rcp_f32 v117, v117
    v_rcp_f32 v118, v118
    v_rcp_f32 v119, v119
    s_nop 0
    v_mul_f32 v128, v120, v112
    v_mul_f32 v129, v121, v113
    v_mul_f32 v130, v122, v114
    v_mul_f32 v131, v123, v115
    v_mul_f32 v132, v124, v116
    v_mul_f32 v133, v125, v117
    v_mul_f32 v134, v126, v118
    v_mul_f32 v135, v127, v119
    v_cvt_pk_bf16_f32 v136, v128, v129
    v_cvt_pk_bf16_f32 v137, v130, v131
    v_cvt_pk_bf16_f32 v138, v132, v133
    v_cvt_pk_bf16_f32 v139, v134, v135
    s_nop 1
    v_mfma_f32_32x32x16_bf16 v[48:63], v[136:139], v[224:227], v[48:63]
    s_branch K2_EPI
K2B_EXIT0:
    v_cvt_pk_bf16_f32 v136, v128, v129
    v_cvt_pk_bf16_f32 v137, v130, v131
    v_cvt_pk_bf16_f32 v138, v132, v133
    v_cvt_pk_bf16_f32 v139, v134, v135
    v_rcp_f32 v112, v112
    v_rcp_f32 v113, v113
    v_mfma_f32_32x32x16_bf16 v[32:47], v[136:139], v[164:167], v[32:47]
    v_rcp_f32 v114, v114
    v_rcp_f32 v115, v115
    v_rcp_f32 v116, v116
    v_rcp_f32 v117, v117
    v_rcp_f32 v118, v118
    v_rcp_f32 v119, v119
    s_nop 0
    v_mul_f32 v128, v120, v112
    v_mul_f32 v129, v121, v113
    v_mul_f32 v130, v122, v114
    v_mul_f32 v131, v123, v115
    v_mul_f32 v132, v124, v116
    v_mul_f32 v133, v125, v117
    v_mul_f32 v134, v126, v118
    v_mul_f32 v135, v127, v119
    v_cvt_pk_bf16_f32 v136, v128, v129
    v_cvt_pk_bf16_f32 v137, v130, v131
    v_cvt_pk_bf16_f32 v138, v132, v133
    v_cvt_pk_bf16_f32 v139, v134, v135
    s_nop 1
    v_mfma_f32_32x32x16_bf16 v[48:63], v[136:139], v[164:167], v[48:63]
    s_branch K2_EPI
K2_EPI:
    s_mov_b32 s78, 0xbf317218
    s_add_u32 s79, s9, 4096
    buffer_load_dwordx4 v[208:211], v4, s[40:43], s79 offen offset:1024
    buffer_load_dwordx4 v[212:215], v4, s[40:43], s79 offen offset:2048
    buffer_load_dwordx4 v[216:219], v4, s[40:43], s79 offen offset:3072
    s_add_u32 s79, s9, 8192
    buffer_load_dwordx4 v[220:223], v4, s[40:43], s79 offen offset:0
    v_add_u32 v240, s64, v4
    s_waitcnt vmcnt(4)
    v_cvt_pk_bf16_f32 v96, v32, v33
    v_cvt_pk_bf16_f32 v97, v34, v35
    v_cvt_pk_bf16_f32 v98, v36, v37
    v_cvt_pk_bf16_f32 v99, v38, v39
    ds_write_b128 v240, v[96:99] offset:0
    v_cvt_pk_bf16_f32 v100, v40, v41
    v_cvt_pk_bf16_f32 v101, v42, v43
    v_cvt_pk_bf16_f32 v102, v44, v45
    v_cvt_pk_bf16_f32 v103, v46, v47
    ds_write_b128 v240, v[100:103] offset:1024
    v_cvt_pk_bf16_f32 v104, v48, v49
    v_cvt_pk_bf16_f32 v105, v50, v51
    v_cvt_pk_bf16_f32 v106, v52, v53
    v_cvt_pk_bf16_f32 v107, v54, v55
    ds_write_b128 v240, v[104:107] offset:2048
    v_cvt_pk_bf16_f32 v108, v56, v57
    v_cvt_pk_bf16_f32 v109, v58, v59
    v_cvt_pk_bf16_f32 v110, v60, v61
    v_cvt_pk_bf16_f32 v111, v62, v63
    ds_write_b128 v240, v[108:111] offset:3072
    v_lshrrev_b32 v144, 4, v1
    v_and_b32 v143, 15, v1
    s_sub_u32 s76, s17, 16
    v_lshl_add_u32 v236, v144, 8, v4
    v_cmp_le_u32 vcc, s76, v143
    v_add_u32 v236, 98304, v236
    v_add_u32 v237, 256, v236
    s_mov_b64 exec, vcc
    v_add_u32 v237, 0x8000, v236
    s_mov_b64 exec, -1
    s_waitcnt lgkmcnt(0)
    s_barrier
    ds_read_b128 v[32:35], v236 offset:0
    ds_read_b128 v[36:39], v237 offset:0
    ds_read_b128 v[40:43], v236 offset:33024
    ds_read_b128 v[44:47], v236 offset:2048
    ds_read_b128 v[48:51], v237 offset:2048
    ds_read_b128 v[52:55], v236 offset:35072
    ds_read_b128 v[56:59], v236 offset:8192
    ds_read_b128 v[60:63], v237 offset:8192
    v_lshlrev_b32 v145, 2, v143
    v_add_u32 v146, 64, v145
    v_add_u32 v147, 128, v145
    v_lshlrev_b32 v238, 3, v144
    ds_bpermute_b32 v228, v145, v182
    ds_bpermute_b32 v229, v146, v182
    ds_bpermute_b32 v230, v147, v182
    s_waitcnt lgkmcnt(10)
    v_mfma_f32_16x16x32_bf16 v[64:67], v[188:191], v[32:35], 0
    ds_read_b128 v[32:35], v236 offset:41216
    s_movk_i32 s76, 272
    v_mad_u32_u24 v238, v143, s76, v238
    s_waitcnt lgkmcnt(10)
    v_mfma_f32_16x16x32_bf16 v[68:71], v[188:191], v[36:39], 0
    ds_read_b128 v[36:39], v236 offset:10240
    s_lshl_b32 s77, s3, 5
    v_add_u32 v238, s77, v238
    s_waitcnt lgkmcnt(10)
    v_mfma_f32_16x16x32_bf16 v[72:75], v[188:191], v[40:43], 0
    ds_read_b128 v[40:43], v237 offset:10240
    v_lshlrev_b32 v239, 4, v143
    v_mad_u32_u24 v239, v144, s76, v239
    s_waitcnt lgkmcnt(10)
    v_mfma_f32_16x16x32_bf16 v[64:67], v[192:195], v[44:47], v[64:67]
    ds_read_b128 v[44:47], v236 offset:43264
    s_mul_i32 s76, s3, 1088
    v_add_u32 v239, s76, v239
    s_waitcnt lgkmcnt(10)
    v_mfma_f32_16x16x32_bf16 v[68:71], v[192:195], v[48:51], v[68:71]
    ds_read_b128 v[48:51], v236 offset:16384
    s_lshl_b32 s76, s3, 2
    s_sub_u32 s76, s57, s76
    s_waitcnt lgkmcnt(10)
    v_mfma_f32_16x16x32_bf16 v[72:75], v[192:195], v[52:55], v[72:75]
    ds_read_b128 v[52:55], v237 offset:16384
    s_sub_u32 s76, s76, 32
    v_cmp_gt_i32 s[12:13], s76, v144
    s_waitcnt lgkmcnt(10)
    v_mfma_f32_16x16x32_bf16 v[64:67], v[196:199], v[56:59], v[64:67]
    ds_read_b128 v[56:59], v236 offset:49408
    s_lshl_b32 s14, s54, 8
    s_lshl_b32 s76, s3, 10
    s_waitcnt lgkmcnt(10)
    v_mfma_f32_16x16x32_bf16 v[68:71], v[196:199], v[60:63], v[68:71]
    ds_read_b128 v[60:63], v236 offset:18432
    s_add_u32 s14, s14, s76
    s_add_u32 s15, s14, 8192
    s_waitcnt lgkmcnt(7)
    v_mfma_f32_16x16x32_bf16 v[72:75], v[196:199], v[32:35], v[72:75]
    ds_read_b128 v[32:35], v237 offset:18432
    s_waitcnt lgkmcnt(7)
    v_mfma_f32_16x16x32_bf16 v[64:67], v[200:203], v[36:39], v[64:67]
    ds_read_b128 v[36:39], v236 offset:51456
    s_waitcnt lgkmcnt(7)
    v_mfma_f32_16x16x32_bf16 v[68:71], v[200:203], v[40:43], v[68:71]
    ds_read_b128 v[40:43], v236 offset:24576
    s_waitcnt lgkmcnt(7)
    v_mfma_f32_16x16x32_bf16 v[72:75], v[200:203], v[44:47], v[72:75]
    ds_read_b128 v[44:47], v237 offset:24576
    s_waitcnt lgkmcnt(7)
    v_mfma_f32_16x16x32_bf16 v[64:67], v[204:207], v[48:51], v[64:67]
    ds_read_b128 v[48:51], v236 offset:57600
    s_waitcnt lgkmcnt(7)
    v_mfma_f32_16x16x32_bf16 v[68:71], v[204:207], v[52:55], v[68:71]
    ds_read_b128 v[52:55], v236 offset:26624
    s_waitcnt lgkmcnt(7)
    v_mfma_f32_16x16x32_bf16 v[72:75], v[204:207], v[56:59], v[72:75]
    ds_read_b128 v[56:59], v237 offset:26624
    s_waitcnt lgkmcnt(7)
    s_waitcnt vmcnt(3)
    v_mfma_f32_16x16x32_bf16 v[64:67], v[208:211], v[60:63], v[64:67]
    ds_read_b128 v[60:63], v236 offset:59648
    s_waitcnt lgkmcnt(7)
    v_mfma_f32_16x16x32_bf16 v[68:71], v[208:211], v[32:35], v[68:71]
    s_waitcnt lgkmcnt(6)
    v_mfma_f32_16x16x32_bf16 v[72:75], v[208:211], v[36:39], v[72:75]
    s_waitcnt lgkmcnt(5)
    s_waitcnt vmcnt(2)
    v_mfma_f32_16x16x32_bf16 v[64:67], v[212:215], v[40:43], v[64:67]
    s_waitcnt lgkmcnt(4)
    v_mfma_f32_16x16x32_bf16 v[68:71], v[212:215], v[44:47], v[68:71]
    s_waitcnt lgkmcnt(3)
    v_mfma_f32_16x16x32_bf16 v[72:75], v[212:215], v[48:51], v[72:75]
    s_waitcnt lgkmcnt(2)
    s_waitcnt vmcnt(0)
    v_mfma_f32_16x16x32_bf16 v[64:67], v[216:219], v[52:55], v[64:67]
    v_mul_f32 v80, v228, v220
    v_mul_f32 v81, v228, v221
    v_mul_f32 v82, v228, v222
    v_mul_f32 v83, v228, v223
    s_waitcnt lgkmcnt(1)
    v_mfma_f32_16x16x32_bf16 v[68:71], v[216:219], v[56:59], v[68:71]
    v_mul_f32 v84, v229, v220
    v_mul_f32 v85, v229, v221
    v_mul_f32 v86, v229, v222
    v_mul_f32 v87, v229, v223
    s_waitcnt lgkmcnt(0)
    v_mfma_f32_16x16x32_bf16 v[72:75], v[216:219], v[60:63], v[72:75]
    v_mul_f32 v88, v230, v220
    v_mul_f32 v89, v230, v221
    v_mul_f32 v90, v230, v222
    v_mul_f32 v91, v230, v223
    s_nop 3
    v_fma_f32 v64, v64, s78, v80
    v_fma_f32 v65, v65, s78, v81
    v_fma_f32 v66, v66, s78, v82
    v_fma_f32 v67, v67, s78, v83
    v_cvt_pk_bf16_f32 v96, v64, v65
    v_cvt_pk_bf16_f32 v97, v66, v67
    ds_write_b64 v238, v[96:97] offset:0
    v_fma_f32 v68, v68, s78, v84
    v_fma_f32 v69, v69, s78, v85
    v_fma_f32 v70, v70, s78, v86
    v_fma_f32 v71, v71, s78, v87
    v_cvt_pk_bf16_f32 v98, v68, v69
    v_cvt_pk_bf16_f32 v99, v70, v71
    ds_write_b64 v238, v[98:99] offset:4352
    v_fma_f32 v72, v72, s78, v88
    v_fma_f32 v73, v73, s78, v89
    v_fma_f32 v74, v74, s78, v90
    v_fma_f32 v75, v75, s78, v91
    v_cvt_pk_bf16_f32 v100, v72, v73
    v_cvt_pk_bf16_f32 v101, v74, v75
    ds_write_b64 v238, v[100:101] offset:8704
    s_cmp_ge_u32 s3, 2
    s_waitcnt lgkmcnt(0)
    s_barrier
    ds_read_b128 v[96:99], v239
    s_cbranch_scc1 K2_ST1
    ds_read_b128 v[100:103], v239 offset:8704
    s_mov_b64 exec, s[12:13]
    s_waitcnt lgkmcnt(0)
    buffer_store_dwordx4 v[100:103], v4, s[44:47], s15 offen sc0 sc1
    s_mov_b64 exec, -1
K2_ST1:
    s_waitcnt lgkmcnt(0)
    buffer_store_dwordx4 v[96:99], v4, s[44:47], s14 offen sc0 sc1
K2_FIN:
    s_endpgm
K2_CUT2:
    s_add_u32 s76, s76, 32
    s_lshl_b32 s17, s76, 1
    s_sub_u32 s17, s17, 128
    s_cmp_lt_i32 s17, s77
    s_cbranch_scc1 K2_CUT
K2_FIX:
    s_mov_b32 s17, 19
    s_branch K2_CUTD
K2_NF3:
    s_waitcnt vmcnt(0) lgkmcnt(0)
    s_barrier
    s_branch K2_J3
K2_NF4:
    s_waitcnt lgkmcnt(0)
    s_add_u32 m0, s64, 0
    s_nop 0
    buffer_load_dwordx4 v[168:169], s[32:35], 0 idxen offen lds
    s_add_u32 m0, s64, 1024
    s_nop 0
    buffer_load_dwordx4 v[170:171], s[32:35], 0 idxen offen lds
    s_add_u32 m0, s64, 2048
    s_nop 0
    buffer_load_dwordx4 v[172:173], s[32:35], 0 idxen offen lds
    s_add_u32 m0, s64, 3072
    s_nop 0
    buffer_load_dwordx4 v[174:175], s[32:35], 0 idxen offen lds
    ds_read_b32 v168, v181 offset:128
    ds_read_b32 v170, v181 offset:160
    ds_read_b32 v172, v181 offset:192
    ds_read_b32 v174, v181 offset:224
    v_cmpx_le_u32 vcc, s76, v148
    v_add_u32 v148, -64, v148
    s_mov_b64 exec, -1
    v_cmpx_le_u32 vcc, s76, v149
    v_add_u32 v149, -64, v149
    s_mov_b64 exec, -1
    ds_bpermute_b32 v166, v148, v186
    ds_bpermute_b32 v164, v148, v187
    ds_bpermute_b32 v167, v149, v186
    ds_bpermute_b32 v165, v149, v187
    v_add_u32 v5, s69, v163
    v_lshl_add_u32 v152, v148, 2, s8
    v_lshl_add_u32 v153, v149, 2, s8
    s_waitcnt lgkmcnt(0)
    v_lshrrev_b32 v80, 5, v154
    v_mul_u32_u24 v82, v80, v134
    v_mad_u32_u24 v83, v80, v135, v152
    v_lshl_add_u32 v82, v154, 4, v82
    v_mul_u32_u24 v86, v80, v131
    v_and_b32 v84, 4, v154
    v_lshrrev_b32 v85, 1, v154
    v_lshl_add_u32 v83, v84, 7, v83
    v_add_u32 v84, v166, v82
    v_and_or_b32 v83, v85, 12, v83
    v_lshl_add_u32 v86, v154, 2, v86
    v_and_or_b32 v83, v154, 2, v83
    s_mov_b64 exec, s[72:73]
    ds_write2_b32 v82, v140, v141 offset0:0 offset1:128
    ds_write_b16 v84, v132
    ds_write_b32 v86, v164 offset:1024
    ds_write_b16 v83, v132 offset:1152
    s_mov_b64 exec, -1
    v_lshrrev_b32 v80, 5, v155
    v_mul_u32_u24 v82, v80, v134
    v_mad_u32_u24 v83, v80, v135, v153
    v_lshl_add_u32 v82, v155, 4, v82
    v_mul_u32_u24 v86, v80, v131
    v_and_b32 v84, 4, v155
    v_lshrrev_b32 v85, 1, v155
    v_lshl_add_u32 v83, v84, 7, v83
    v_add_u32 v84, v167, v82
    v_and_or_b32 v83, v85, 12, v83
    v_lshl_add_u32 v86, v155, 2, v86
    v_and_or_b32 v83, v155, 2, v83
    s_mov_b64 exec, s[74:75]
    ds_write2_b32 v82, v144, v145 offset0:0 offset1:128
    ds_write_b16 v84, v132
    ds_write_b32 v86, v165 offset:1024
    ds_write_b16 v83, v132 offset:1152
    s_mov_b64 exec, -1
    s_waitcnt lgkmcnt(0)
    s_barrier
    s_add_u32 m0, s64, 4096
    s_nop 0
    buffer_load_dwordx4 v[168:169], s[32:35], 0 idxen offen lds
    s_add_u32 m0, s64, 5120
    s_nop 0
    buffer_load_dwordx4 v[170:171], s[32:35], 0 idxen offen lds
    s_add_u32 m0, s64, 6144
    s_nop 0
    buffer_load_dwordx4 v[172:173], s[32:35], 0 idxen offen lds
    s_add_u32 m0, s64, 7168
    s_nop 0
    buffer_load_dwordx4 v[174:175], s[32:35], 0 idxen offen lds
    s_branch K2_SLOW
K2_OV:
    s_cmp_eq_u32 s60, 48
    s_cbranch_scc1 K2_NOOV
    s_mov_b32 s60, 48
    s_add_u32 s78, s78, 47
    s_mul_hi_u32 s10, s78, 0x5555556
    s_waitcnt lgkmcnt(0)
    s_barrier
K2_BATCH:
    v_mov_b32 v128, 0
    s_lshl_b32 m0, s3, 8
    s_nop 0
    ds_write_addtid_b32 v128 offset:0
    ds_write_addtid_b32 v128 offset:2048
    ds_write_addtid_b32 v128 offset:4096
    ds_write_addtid_b32 v128 offset:6144
    ds_write_addtid_b32 v128 offset:8192
    ds_write_addtid_b32 v128 offset:10240
    ds_write_addtid_b32 v128 offset:12288
    ds_write_addtid_b32 v128 offset:14336
    ds_write_addtid_b32 v128 offset:16384
    ds_write_addtid_b32 v128 offset:18432
    ds_write_addtid_b32 v128 offset:20480
    ds_write_addtid_b32 v128 offset:22528
    ds_write_addtid_b32 v128 offset:24576
    ds_write_addtid_b32 v128 offset:26624
    ds_write_addtid_b32 v128 offset:28672
    ds_write_addtid_b32 v128 offset:30720
    ds_write_addtid_b32 v128 offset:32768
    ds_write_addtid_b32 v128 offset:34816
    ds_write_addtid_b32 v128 offset:36864
    ds_write_addtid_b32 v128 offset:38912
    ds_write_addtid_b32 v128 offset:40960
    ds_write_addtid_b32 v128 offset:43008
    ds_write_addtid_b32 v128 offset:45056
    ds_write_addtid_b32 v128 offset:47104
    ds_write_addtid_b32 v128 offset:49152
    ds_write_addtid_b32 v128 offset:51200
    ds_write_addtid_b32 v128 offset:53248
    s_min_u32 s76, s3, 6
    s_lshl_b32 m0, s76, 8
    s_nop 0
    ds_write_addtid_b32 v128 offset:55296
    v_lshl_add_u32 v160, v1, 2, s6
    v_add_u32 v161, 64, v1
    s_branch K2_GEN
K2_GEN0:
    v_readlane_b32 s58, v183, 63
    v_sub_u32 v183, v183, v184
K2_GEN:
    s_add_u32 s76, s59, s60
    s_lshl_b32 s78, s59, 2
    s_sub_u32 s78, s6, s78
    v_max_u32 v6, s59, v183
    v_add_u32 v7, v183, v184
    v_min_u32 v7, s76, v7
    v_sub_u32 v156, v6, v183
    v_mad_u32_u24 v156, v156, 48, v185
    v_sub_u32 v7, v7, v6
    v_lshl_add_u32 v6, v6, 2, s78
K2_EXP:
    v_cmpx_lt_i32 vcc, 0, v7
    ds_write_b32 v6, v156 offset:0
    v_add_u32 v156, 48, v156
    v_cmpx_lt_i32 vcc, 1, v7
    ds_write_b32 v6, v156 offset:4
    v_add_u32 v156, 48, v156
    v_cmpx_lt_i32 vcc, 2, v7
    ds_write_b32 v6, v156 offset:8
    v_add_u32 v156, 48, v156
    v_cmpx_lt_i32 vcc, 3, v7
    ds_write_b32 v6, v156 offset:12
    v_add_u32 v156, 48, v156
    v_cmpx_lt_i32 vcc, 4, v7
    v_add_u32 v6, 16, v6
    v_subrev_u32 v7, 4, v7
    s_sub_u32 s76, s58, s59
    s_max_i32 s76, s76, 0
    s_min_u32 s76, s76, s60
    s_nop 1
    s_cbranch_execnz K2_EXP
    s_branch K2_LISTED
K2_SLOW0:
    s_mov_b32 s61, s10
K2_SLOW:
    s_mov_b32 s63, s62
    s_cmp_lg_u32 s68, 0
    s_cbranch_scc1 K2_SL1
    v_mov_b32 v32, 0
    v_mov_b32 v33, 0
    v_mov_b32 v34, 0
    v_mov_b32 v35, 0
    v_mov_b32 v36, 0
    v_mov_b32 v37, 0
    v_mov_b32 v38, 0
    v_mov_b32 v39, 0
    v_mov_b32 v40, 0
    v_mov_b32 v41, 0
    v_mov_b32 v42, 0
    v_mov_b32 v43, 0
    v_mov_b32 v44, 0
    v_mov_b32 v45, 0
    v_mov_b32 v46, 0
    v_mov_b32 v47, 0
    v_mov_b32 v48, 0
    v_mov_b32 v49, 0
    v_mov_b32 v50, 0
    v_mov_b32 v51, 0
    v_mov_b32 v52, 0
    v_mov_b32 v53, 0
    v_mov_b32 v54, 0
    v_mov_b32 v55, 0
    v_mov_b32 v56, 0
    v_mov_b32 v57, 0
    v_mov_b32 v58, 0
    v_mov_b32 v59, 0
    v_mov_b32 v60, 0
    v_mov_b32 v61, 0
    v_mov_b32 v62, 0
    v_mov_b32 v63, 0
    s_mov_b32 s68, 1
K2_SL1:
    s_cmp_eq_u32 s62, 0
    s_cbranch_scc1 K2_BDONE
    s_mov_b32 s77, s64
K2_SLOOP:
    s_waitcnt vmcnt(0)
    ds_read_b128 v[140:143], v176 offset:0
    ds_read_b128 v[144:147], v177 offset:0
    ds_read_b128 v[148:151], v178 offset:0
    ds_read_b128 v[152:155], v179 offset:0
    ds_read_b128 v[156:159], v180 offset:0
    ds_read_u16 v160, v5 offset:1024
    ds_read_b128 v[164:167], v180 offset:1152
    ds_read_b32 v168, v181 offset:256
    ds_read_b32 v170, v181 offset:288
    ds_read_b32 v172, v181 offset:320
    ds_read_b32 v174, v181 offset:352
    s_waitcnt lgkmcnt(0)
    s_add_u32 m0, s64, 0
    s_nop 0
    buffer_load_dwordx4 v[168:169], s[32:35], 0 idxen offen lds
    s_add_u32 m0, s64, 1024
    s_nop 0
    buffer_load_dwordx4 v[170:171], s[32:35], 0 idxen offen lds
    s_add_u32 m0, s64, 2048
    s_nop 0
    buffer_load_dwordx4 v[172:173], s[32:35], 0 idxen offen lds
    s_add_u32 m0, s64, 3072
    s_nop 0
    buffer_load_dwordx4 v[174:175], s[32:35], 0 idxen offen lds
    v_mfma_f32_32x32x16_bf16 v[64:79], v[140:143], v[8:11], 0
    v_mfma_f32_32x32x16_bf16 v[64:79], v[144:147], v[12:15], v[64:79]
    v_smfmac_f32_32x32x32_bf16 v[64:79], v[156:159], v[16:23], v160
    s_nop 15
    v_exp_f32 v96, v64
    v_exp_f32 v97, v65
    v_exp_f32 v98, v66
    v_exp_f32 v99, v67
    v_exp_f32 v100, v68
    v_exp_f32 v101, v69
    v_exp_f32 v102, v70
    v_exp_f32 v103, v71
    v_exp_f32 v104, v72
    v_exp_f32 v105, v73
    v_exp_f32 v106, v74
    v_exp_f32 v107, v75
    v_exp_f32 v108, v76
    v_exp_f32 v109, v77
    v_exp_f32 v110, v78
    v_exp_f32 v111, v79
    v_add_f32 v96, 1.0, v96
    v_add_f32 v97, 1.0, v97
    v_add_f32 v98, 1.0, v98
    v_add_f32 v99, 1.0, v99
    v_add_f32 v100, 1.0, v100
    v_add_f32 v101, 1.0, v101
    v_add_f32 v102, 1.0, v102
    v_add_f32 v103, 1.0, v103
    v_add_f32 v104, 1.0, v104
    v_add_f32 v105, 1.0, v105
    v_add_f32 v106, 1.0, v106
    v_add_f32 v107, 1.0, v107
    v_add_f32 v108, 1.0, v108
    v_add_f32 v109, 1.0, v109
    v_add_f32 v110, 1.0, v110
    v_add_f32 v111, 1.0, v111
    v_rcp_f32 v96, v96
    v_rcp_f32 v97, v97
    v_rcp_f32 v98, v98
    v_rcp_f32 v99, v99
    v_rcp_f32 v100, v100
    v_rcp_f32 v101, v101
    v_rcp_f32 v102, v102
    v_rcp_f32 v103, v103
    v_rcp_f32 v104, v104
    v_rcp_f32 v105, v105
    v_rcp_f32 v106, v106
    v_rcp_f32 v107, v107
    v_rcp_f32 v108, v108
    v_rcp_f32 v109, v109
    v_rcp_f32 v110, v110
    v_rcp_f32 v111, v111
    v_mul_f32 v128, v64, v96
    v_mul_f32 v129, v66, v98
    v_mul_f32 v130, v68, v100
    v_mul_f32 v131, v70, v102
    v_mul_f32 v132, v72, v104
    v_mul_f32 v133, v74, v106
    v_mul_f32 v134, v76, v108
    v_mul_f32 v135, v78, v110
    v_fma_f32 v128, v65, v97, v128
    v_fma_f32 v129, v67, v99, v129
    v_fma_f32 v130, v69, v101, v130
    v_fma_f32 v131, v71, v103, v131
    v_fma_f32 v132, v73, v105, v132
    v_fma_f32 v133, v75, v107, v133
    v_fma_f32 v134, v77, v109, v134
    v_fma_f32 v135, v79, v111, v135
    v_cvt_pk_bf16_f32 v136, v128, v129
    v_cvt_pk_bf16_f32 v137, v130, v131
    v_cvt_pk_bf16_f32 v138, v132, v133
    v_cvt_pk_bf16_f32 v139, v134, v135
    s_nop 1
    v_mfma_f32_32x32x16_bf16 v[32:47], v[136:139], v[164:167], v[32:47]
    v_mfma_f32_32x32x16_bf16 v[80:95], v[148:151], v[8:11], 0
    v_mfma_f32_32x32x16_bf16 v[80:95], v[152:155], v[12:15], v[80:95]
    v_smfmac_f32_32x32x32_bf16 v[80:95], v[156:159], v[24:31], v160
    s_nop 15
    v_exp_f32 v96, v80
    v_exp_f32 v97, v81
    v_exp_f32 v98, v82
    v_exp_f32 v99, v83
    v_exp_f32 v100, v84
    v_exp_f32 v101, v85
    v_exp_f32 v102, v86
    v_exp_f32 v103, v87
    v_exp_f32 v104, v88
    v_exp_f32 v105, v89
    v_exp_f32 v106, v90
    v_exp_f32 v107, v91
    v_exp_f32 v108, v92
    v_exp_f32 v109, v93
    v_exp_f32 v110, v94
    v_exp_f32 v111, v95
    v_add_f32 v96, 1.0, v96
    v_add_f32 v97, 1.0, v97
    v_add_f32 v98, 1.0, v98
    v_add_f32 v99, 1.0, v99
    v_add_f32 v100, 1.0, v100
    v_add_f32 v101, 1.0, v101
    v_add_f32 v102, 1.0, v102
    v_add_f32 v103, 1.0, v103
    v_add_f32 v104, 1.0, v104
    v_add_f32 v105, 1.0, v105
    v_add_f32 v106, 1.0, v106
    v_add_f32 v107, 1.0, v107
    v_add_f32 v108, 1.0, v108
    v_add_f32 v109, 1.0, v109
    v_add_f32 v110, 1.0, v110
    v_add_f32 v111, 1.0, v111
    v_rcp_f32 v96, v96
    v_rcp_f32 v97, v97
    v_rcp_f32 v98, v98
    v_rcp_f32 v99, v99
    v_rcp_f32 v100, v100
    v_rcp_f32 v101, v101
    v_rcp_f32 v102, v102
    v_rcp_f32 v103, v103
    v_rcp_f32 v104, v104
    v_rcp_f32 v105, v105
    v_rcp_f32 v106, v106
    v_rcp_f32 v107, v107
    v_rcp_f32 v108, v108
    v_rcp_f32 v109, v109
    v_rcp_f32 v110, v110
    v_rcp_f32 v111, v111
    v_mul_f32 v128, v80, v96
    v_mul_f32 v129, v82, v98
    v_mul_f32 v130, v84, v100
    v_mul_f32 v131, v86, v102
    v_mul_f32 v132, v88, v104
    v_mul_f32 v133, v90, v106
    v_mul_f32 v134, v92, v108
    v_mul_f32 v135, v94, v110
    v_fma_f32 v128, v81, v97, v128
    v_fma_f32 v129, v83, v99, v129
    v_fma_f32 v130, v85, v101, v130
    v_fma_f32 v131, v87, v103, v131
    v_fma_f32 v132, v89, v105, v132
    v_fma_f32 v133, v91, v107, v133
    v_fma_f32 v134, v93, v109, v134
    v_fma_f32 v135, v95, v111, v135
    v_cvt_pk_bf16_f32 v136, v128, v129
    v_cvt_pk_bf16_f32 v137, v130, v131
    v_cvt_pk_bf16_f32 v138, v132, v133
    v_cvt_pk_bf16_f32 v139, v134, v135
    s_nop 1
    v_mfma_f32_32x32x16_bf16 v[48:63], v[136:139], v[164:167], v[48:63]
    v_xor_b32 v176, 0x1000, v176
    v_xor_b32 v177, 0x1000, v177
    v_xor_b32 v178, 0x1000, v178
    v_xor_b32 v179, 0x1000, v179
    s_xor_b32 s64, s64, 0x1000
    v_add_u32 v180, 2176, v180
    v_add_u32 v5, 2176, v5
    v_add_u32 v181, 128, v181
    s_sub_u32 s63, s63, 1
    s_cmp_lg_u32 s63, 0
    s_cbranch_scc1 K2_SLOOP
    s_xor_b32 s76, s77, s64
    s_mov_b32 s64, s77
    v_xor_b32 v176, s76, v176
    v_xor_b32 v177, s76, v177
    v_xor_b32 v178, s76, v178
    v_xor_b32 v179, s76, v179
K2_BDONE:
    s_add_u32 s59, s59, s60
    s_sub_u32 s61, s61, 1
    s_cmp_eq_u32 s61, 0
    s_cbranch_scc1 K2_EPI
    s_waitcnt vmcnt(0) lgkmcnt(0)
    s_barrier
    s_branch K2_BATCH
K2_END:
    s_endpgm
.section .rodata,"a"
.p2align 6
.amdhsa_kernel mpnn_pre_kernel
  .amdhsa_next_free_vgpr 128
  .amdhsa_next_free_sgpr 80
  .amdhsa_accum_offset 128
  .amdhsa_group_segment_fixed_size 0
  .amdhsa_kernarg_size 88
  .amdhsa_user_sgpr_count 2
  .amdhsa_user_sgpr_kernarg_segment_ptr 1
  .amdhsa_system_sgpr_workgroup_id_x 1
.end_amdhsa_kernel
.section .rodata,"a"
.p2align 6
.amdhsa_kernel mpnn_main_kernel
  .amdhsa_next_free_vgpr 256
  .amdhsa_next_free_sgpr 80
  .amdhsa_accum_offset 256
  .amdhsa_group_segment_fixed_size 0
  .amdhsa_kernarg_size 88
  .amdhsa_user_sgpr_count 2
  .amdhsa_user_sgpr_kernarg_segment_ptr 1
  .amdhsa_system_sgpr_workgroup_id_x 1
.end_amdhsa_kernel
```
